```python
import torch

def _softmax(x, axis=-1):
    return torch.softmax(x, dim=axis)

def _gelu(x):
    return torch.nn.functional.gelu(x, approximate='tanh')

def _silu(x):
    return torch.nn.functional.silu(x)

def _sigmoid(x):
    return torch.sigmoid(x)

def _layernorm(x, axis=-1, eps=1e-05):
    m = x.mean(dim=axis, keepdim=True)
    v = x.var(dim=axis, keepdim=True, unbiased=False)
    return (x - m) / torch.sqrt(v + eps)

def _scatter_add(tgt, idx, src, axis=0):
    return tgt.clone().index_add_(axis, idx, src)

def _segment_sum(src, seg, n):
    out = torch.zeros((n,) + src.shape[1:], dtype=src.dtype)
    return out.index_add_(0, seg, src)

def _pad(x, pw):
    flat = tuple((v for pair in reversed(pw) for v in pair))
    return torch.nn.functional.pad(x, flat)
kernel_name = 'adaLN_cond__sliding_block_cached__glu_gated_geglu__decode'

def setup_inputs():

    _w = lambda a: (lambda t: t.to(torch.bfloat16) if t.is_floating_point() else t)(torch.as_tensor(a))

    def _A_setup():
        B, Sq, D = (1, 1, 576)
        Hq, Hkv, Sk, Dh = (32, 16, 65536, 128)
        assert Hq % Hkv == 0, (Hq, Hkv)
        return {'x': _w((lambda *s: torch.randn(*s, dtype=torch.bfloat16) * 0.1)(B, Sq, D)), 'k_cache': _w((lambda *s: torch.randn(*s, dtype=torch.bfloat16) * 0.8)(B, Hkv, Sk, Dh)), 'v_cache': _w((lambda *s: torch.randn(*s, dtype=torch.bfloat16) * 3.2)(B, Hkv, Sk, Dh)), 'wq': _w((lambda *s: torch.randn(*s, dtype=torch.bfloat16) * 0.8)(D, Hq * Dh) * D ** (-0.5)), 'wo': _w((lambda *s: torch.randn(*s, dtype=torch.bfloat16) * 3.2)(Hq * Dh, D) * (Hq * Dh) ** (-0.5))}
    _A_in = _A_setup()

    def _B_setup():
        B, S, Dm, Df = (1, 1, 576, 4608)
        return {'x': _w((lambda *s: torch.randn(*s, dtype=torch.bfloat16) * 0.1)(B, S, Dm)), 'w_gate': _w((lambda *s: torch.randn(*s, dtype=torch.bfloat16) * 3.2)(Dm, Df) * Dm ** (-0.5)), 'w_up': _w((lambda *s: torch.randn(*s, dtype=torch.bfloat16) * 3.2)(Dm, Df) * Dm ** (-0.5)), 'w_down': _w((lambda *s: torch.randn(*s, dtype=torch.bfloat16) * 3.2)(Df, Dm) * Df ** (-0.5))}
    _B_in = _B_setup()
    return {'A_x': _A_in['x'], 'A_k_cache': _A_in['k_cache'], 'A_v_cache': _A_in['v_cache'], 'A_wq': _A_in['wq'], 'A_wo': _A_in['wo'], 'B_x': _B_in['x'], 'B_w_gate': _B_in['w_gate'], 'B_w_up': _B_in['w_up'], 'B_w_down': _B_in['w_down'], 'c': _w((lambda *s: torch.randn(*s, dtype=torch.bfloat16) * 0.8)(1, 576) * 8.0), 'w_mod': _w((lambda *s: torch.randn(*s, dtype=torch.bfloat16) * 0.8)(576, 6 * 576) * 576 ** (-0.5) * 8.0)}

def reference(A_x, A_k_cache, A_v_cache, A_wq, A_wo, B_x, B_w_gate, B_w_up, B_w_down, c, w_mod):

    def _A_ref(x, k_cache, v_cache, wq, wo):
        B, Sq, D = x.shape
        Hq, Dh = (32, 128)
        Hkv, Sk = (k_cache.shape[1], k_cache.shape[2])
        W = min(4096, max(256, Sk // 4))
        rep = Hq // Hkv
        q = (lambda x, *d: x.permute(*d))((x @ wq).reshape(B, Sq, Hq, Dh), 0, 2, 1, 3)
        k = (lambda x, n, axis: torch.repeat_interleave(x, n, dim=axis))(k_cache[:, :, Sk - W:, :], rep, axis=1)
        v = (lambda x, n, axis: torch.repeat_interleave(x, n, dim=axis))(v_cache[:, :, Sk - W:, :], rep, axis=1)
        scores = torch.einsum('bhqd,bhkd->bhqk', q, k) * Dh ** (-0.5)
        p = _softmax(scores, axis=-1)
        o = torch.einsum('bhqk,bhkd->bhqd', p, v)
        return (lambda x, *d: x.permute(*d))(o, 0, 2, 1, 3).reshape(B, Sq, Hq * Dh) @ wo

    def _B_ref(x, w_gate, w_up, w_down):
        g = torch.einsum('bsd,df->bsf', x, w_gate)
        u = torch.einsum('bsd,df->bsf', x, w_up)
        h = _gelu(g) * u
        return torch.einsum('bsf,fd->bsd', h, w_down)
    x = A_x
    mod = (_silu(c) @ w_mod).reshape(c.shape[0], 6, 1, -1)
    sa, ca, ga, sb, cb, gb = (mod[:, 0].clone(), mod[:, 1].clone(), mod[:, 2].clone(), mod[:, 3].clone(), mod[:, 4].clone(), mod[:, 5].clone())
    h = _layernorm(x, axis=-1) * (1 + ca) + sa
    x = x + ga * _A_ref(h, A_k_cache, A_v_cache, A_wq, A_wo)
    h = _layernorm(x, axis=-1) * (1 + cb) + sb
    x = x + gb * _B_ref(h, B_w_gate, B_w_up, B_w_down)
    return x
```

```asm
; @launch grid=(256,1,1) block=(512,1,1) lds=14848
.amdgcn_target "amdgcn-amd-amdhsa--gfx950"
.text
.globl adaLN_cond__sliding_block_cached__glu_gated_geglu__decode_kernel
.p2align 8
.type adaLN_cond__sliding_block_cached__glu_gated_geglu__decode_kernel,@function
adaLN_cond__sliding_block_cached__glu_gated_geglu__decode_kernel:
    s_cmp_ge_u32 s2, 256
    s_cbranch_scc1 L_end
    s_load_dwordx16 s[16:31], s[0:1], 0
    s_getpc_b64 s[8:9]
L_pc:
    .set CODE_LEFT, L_code_end - L_pc
    v_lshlrev_b32 v16, 7, v0
    v_min_u32 v16, CODE_LEFT-4, v16
    v_mov_b32 v17, s9
    v_add_co_u32 v16, vcc, s8, v16
    s_nop 1
    v_addc_co_u32 v17, vcc, 0, v17, vcc
    global_load_dword v205, v[16:17], off
    s_load_dwordx8 s[32:39], s[0:1], 64
    s_load_dwordx4 s[40:43], s[0:1], 96
    v_lshrrev_b32 v16, 6, v0
    v_and_b32 v0, 63, v0
    v_readfirstlane_b32 s5, v16
    v_lshlrev_b32 v1, 4, v0
    s_and_b32 s3, s2, 7
    s_lshr_b32 s4, s2, 3
    s_lshl_b32 s12, s3, 1
    s_lshr_b32 s13, s4, 4
    s_add_u32 s12, s12, s13
    s_lshl_b32 s12, s12, 24
    s_add_u32 s12, s12, 15728640
    s_and_b32 s13, s4, 15
    s_mul_i32 s94, s13, 851968
    s_mov_b32 s50, 0x100000
    s_mov_b32 s51, 0x20000
    s_lshl_b32 s95, s5, 10
    v_and_b32 v16, 15, v0
    v_lshlrev_b32 v16, 6, v16
    v_and_b32 v17, 0x30, v0
    v_add3_u32 v14, v16, v17, s95
    s_cmp_lt_u32 s4, 18
    s_cselect_b32 s15, s5, 1
    s_cmp_lg_u32 s15, 0
    s_cbranch_scc1 L_nomod
    v_lshrrev_b32 v16, 3, v0
    v_and_b32 v17, 0x70, v1
    v_mul_u32_u24 v16, 6912, v16
    v_lshl_add_u32 v12, v16, 3, v17
    v_add_u32 v16, 387072, v16
    v_add_u32 v13, v16, v17
    v_lshlrev_b32 v18, 1, v0
    v_lshrrev_b32 v19, 3, v0
    v_lshlrev_b32 v19, 1, v19
    s_mul_i32 s14, s3, 497664
    s_lshl_b32 s8, s4, 7
    s_add_u32 s14, s14, s8
    s_mul_i32 s8, s3, 144
    s_mov_b32 s66, 1152
    s_mov_b32 s67, 0x20000
    s_mov_b32 s58, 3981312
    s_mov_b32 s59, 0x20000
    s_waitcnt lgkmcnt(0)
    s_mov_b32 s64, s34
    s_mov_b32 s65, s35
    s_mov_b32 s56, s36
    s_mov_b32 s57, s37
    buffer_load_ushort v30, v18, s[64:67], s8 offen
    buffer_load_ushort v31, v19, s[64:67], s8 offen offset:128
    buffer_load_dwordx4 v[128:131], v12, s[56:59], s14 offen nt
    s_add_u32 s14, s14, 6912
    buffer_load_dwordx4 v[132:135], v12, s[56:59], s14 offen nt
    s_add_u32 s14, s14, 6912
    buffer_load_dwordx4 v[136:139], v12, s[56:59], s14 offen nt
    s_add_u32 s14, s14, 6912
    buffer_load_dwordx4 v[140:143], v12, s[56:59], s14 offen nt
    s_add_u32 s14, s14, 6912
    buffer_load_dwordx4 v[144:147], v12, s[56:59], s14 offen nt
    s_add_u32 s14, s14, 6912
    buffer_load_dwordx4 v[148:151], v12, s[56:59], s14 offen nt
    s_add_u32 s14, s14, 6912
    buffer_load_dwordx4 v[152:155], v12, s[56:59], s14 offen nt
    s_add_u32 s14, s14, 6912
    buffer_load_dwordx4 v[156:159], v12, s[56:59], s14 offen nt
    s_add_u32 s14, s14, 6912
    buffer_load_dwordx4 v[160:163], v13, s[56:59], s14 offen nt
    s_add_u32 s14, s14, 6912
L_nomod:
    s_waitcnt lgkmcnt(0)
    s_add_u32 s48, s18, s12
    s_addc_u32 s49, s19, 0
    s_load_dwordx2 s[26:27], s[42:43], 0
    s_add_u32 s77, s94, 0
    s_and_b32 s77, s77, 0xfffff
    buffer_load_dwordx4 v[64:67], v14, s[48:51], s77 offen nt
    s_add_u32 s77, s94, 368640
    s_and_b32 s77, s77, 0xfffff
    buffer_load_dwordx4 v[68:71], v14, s[48:51], s77 offen nt
    s_lshl_b32 s8, s4, 3
    s_or_b32 s8, s8, s5
    s_cmp_lg_u32 s8, 0xf8
    s_cbranch_scc1 L_tw1
    v_lshlrev_b32 v16, 21, v0
    s_mov_b64 exec, 7
    global_load_dword v205, v16, s[22:23]
    global_load_dword v205, v16, s[24:25]
    s_mov_b64 exec, 1
    global_load_dword v205, v16, s[16:17]
    s_sub_u32 s10, s12, 0x1000000
    s_add_u32 s8, s20, s10
    s_addc_u32 s9, s21, 0
    s_mov_b64 exec, 0x101
    global_load_dword v205, v16, s[8:9]
    s_mov_b64 exec, 7
    global_load_dword v205, v16, s[28:29]
    global_load_dword v205, v16, s[30:31]
    global_load_dword v205, v16, s[32:33]
    s_mov_b64 exec, -1
L_tw1:
    s_mov_b32 s72, 0x3ff
    s_mov_b32 s73, 0xffff0000
    s_mov_b32 s74, 0
    v_add_u32 v210, s95, v1
    s_mov_b32 s44, s42
    s_mov_b32 s45, s43
    s_mov_b32 s46, 2097152
    s_mov_b32 s47, 0x20000
    s_add_u32 s52, s20, s12
    s_addc_u32 s53, s21, 0
    s_mov_b32 s54, 0x100000
    s_mov_b32 s55, 0x20000
    s_mov_b32 s75, 0x07060302
    s_mov_b32 s76, 0x3fb8aa3b
    s_mov_b32 s82, -1
    s_mov_b32 s83, 15
    s_mov_b32 s84, 0x00ff00ff
    s_mov_b32 s85, 0x00ff00ff
    s_mov_b32 s86, 0x0f0f0f0f
    s_mov_b32 s87, 0x0f0f0f0f
    s_mov_b32 s88, 0xaaaaaaaa
    s_mov_b32 s89, 0xaaaaaaaa
    s_mov_b32 s90, 0
    s_mov_b32 s91, -1
    v_mov_b32 v16, 0xffff
    v_mov_b32 v17, s73
    v_cndmask_b32 v16, v16, v17, s[88:89]
    v_bfe_u32 v17, v0, 1, 2
    v_cmp_eq_u32 vcc, 0, v17
    s_nop 1
    v_cndmask_b32 v2, 0, v16, vcc
    v_cmp_eq_u32 vcc, 1, v17
    s_nop 1
    v_cndmask_b32 v3, 0, v16, vcc
    v_cmp_eq_u32 vcc, 2, v17
    s_nop 1
    v_cndmask_b32 v4, 0, v16, vcc
    v_cmp_eq_u32 vcc, 3, v17
    s_nop 1
    v_cndmask_b32 v5, 0, v16, vcc
    v_and_b32 v16, 15, v0
    v_lshlrev_b32 v16, 5, v16
    v_and_b32 v17, 16, v0
    v_lshrrev_b32 v18, 5, v0
    v_lshlrev_b32 v18, 3, v18
    v_add3_u32 v203, v16, v17, v18
    v_lshlrev_b32 v234, 2, v0
    v_lshrrev_b32 v16, 4, v0
    v_mul_u32_u24 v17, 272, v16
    v_and_b32 v18, 0xf0, v1
    v_add_u32 v208, v17, v18
    v_lshl_add_u32 v209, v16, 2, v18
    s_mul_i32 s8, s5, 272
    v_and_b32 v16, 1, v0
    v_lshlrev_b32 v16, 5, v16
    v_and_b32 v17, 16, v0
    v_lshrrev_b32 v18, 5, v0
    v_lshlrev_b32 v18, 3, v18
    v_add3_u32 v16, v16, v17, v18
    v_bfe_u32 v17, v0, 1, 2
    v_add_lshl_u32 v16, v16, v17, 2
    v_add_u32 v204, s8, v16
    v_add_u32 v211, 16, v204
    s_waitcnt lgkmcnt(0)
    s_add_u32 s26, s26, 0x40100401
    s_addc_u32 s27, s27, 0
    v_mov_b32 v206, s26
    v_mov_b32 v207, s27
    v_and_b32 v6, s72, v206
    v_bfe_u32 v7, v206, 10, 10
    v_bfe_u32 v8, v206, 20, 10
    v_alignbit_b32 v9, v207, v206, 30
    v_and_b32 v9, s72, v9
    v_cndmask_b32 v10, v6, v8, s[88:89]
    v_cndmask_b32 v11, v7, v9, s[88:89]
    v_cndmask_b32 v200, v6, v8, s[90:91]
    v_cndmask_b32 v201, v7, v9, s[90:91]
    v_and_b32 v16, 16, v0
    v_cmp_ne_u32 vcc, 0, v16
    s_nop 1
    v_cndmask_b32 v202, v200, v201, vcc
    v_and_b32 v16, 3, v0
    v_mul_u32_u24 v16, 10, v16
    v_lshrrev_b64 v[18:19], v16, v[206:207]
    v_and_b32 v216, s72, v18
    v_bfe_u32 v16, v0, 3, 2
    v_mul_u32_u24 v16, 10, v16
    v_lshrrev_b64 v[18:19], v16, v[206:207]
    v_and_b32 v217, s72, v18
    s_cmp_lg_u32 s5, 2
    s_cbranch_scc1 L_cen2
    s_getreg_b32 s8, hwreg(HW_REG_XCC_ID)
    s_and_b32 s8, s8, 0xff
    s_lshl_b32 s8, s8, 16
    v_or_b32 v16, s8, v216
    s_lshl_b32 s8, s3, 5
    s_add_u32 s8, s8, s4
    s_lshl_b32 s8, s8, 4
    s_add_u32 s8, s8, 1015808
    v_lshlrev_b32 v17, 2, v0
    s_mov_b64 exec, 15
    buffer_store_dword v16, v17, s[44:47], s8 offen
    s_mov_b64 exec, -1
L_cen2:
    s_cmp_ge_u32 s4, 27
    s_cbranch_scc1 L_MR
    s_cmp_ge_u32 s4, 18
    s_cbranch_scc1 L_WD
    s_mov_b32 s6, s4
    s_mov_b32 s60, s22
    s_mov_b32 s61, s23
    s_mov_b32 s62, 4718592
    s_mov_b32 s63, 0x20000
    s_cmp_lg_u32 s5, 1
    s_cbranch_scc1 L_w13
    s_mov_b32 s68, s16
    s_mov_b32 s69, s17
    s_mov_b32 s70, 1152
    s_mov_b32 s71, 0x20000
    buffer_load_dwordx4 v[32:35], v1, s[68:71], 0 offen
    buffer_load_dwordx4 v[36:39], v1, s[68:71], 0 offen offset:1024
    v_and_b32 v16, 7, v0
    v_lshrrev_b32 v17, 4, v0
    v_lshl_add_u32 v28, v16, 2, v17
    v_lshlrev_b32 v16, 1, v28
    s_lshl_b32 s8, s6, 6
    buffer_load_ushort v40, v16, s[68:71], s8 offen
L_w13:
    s_cmp_lg_u32 s5, 0
    s_cbranch_scc1 L_n04
    s_waitcnt vmcnt(11)
    v_lshlrev_b32 v30, 16, v30
    v_lshlrev_b32 v31, 16, v31
    v_mul_f32 v33, 0xbfb8aa3b, v30
    v_mul_f32 v34, 0xbfb8aa3b, v31
    v_exp_f32 v33, v33
    v_exp_f32 v34, v34
    v_add_f32 v33, 1.0, v33
    v_add_f32 v34, 1.0, v34
    v_min_f32 v33, 0x7e800000, v33
    v_rcp_f32 v35, v33
    s_nop 0
    v_mul_f32 v36, v30, v35
    v_fma_f32 v33, -v33, v36, v30
    v_fma_f32 v30, v33, v35, v36
    v_min_f32 v34, 0x7e800000, v34
    v_rcp_f32 v35, v34
    s_nop 0
    v_mul_f32 v36, v31, v35
    v_fma_f32 v34, -v34, v36, v31
    v_fma_f32 v31, v34, v35, v36
    v_cvt_pk_bf16_f32 v30, v30, v30
    v_cvt_pk_bf16_f32 v56, v31, v31
    ds_swizzle_b32 v48, v30 offset:24
    ds_swizzle_b32 v49, v30 offset:56
    ds_swizzle_b32 v50, v30 offset:88
    ds_swizzle_b32 v51, v30 offset:120
    ds_swizzle_b32 v52, v30 offset:152
    ds_swizzle_b32 v53, v30 offset:184
    ds_swizzle_b32 v54, v30 offset:216
    ds_swizzle_b32 v55, v30 offset:248
    s_waitcnt lgkmcnt(7)
    v_and_b32 v32, v48, v2
    v_and_b32 v33, v48, v3
    v_and_b32 v34, v48, v4
    v_and_b32 v35, v48, v5
    s_waitcnt lgkmcnt(6)
    v_and_b32 v36, v49, v2
    v_and_b32 v37, v49, v3
    v_and_b32 v38, v49, v4
    v_and_b32 v39, v49, v5
    s_waitcnt vmcnt(10)
    v_mfma_f32_16x16x32_bf16 v[40:43], v[32:35], v[128:131], 0
    s_waitcnt lgkmcnt(5)
    v_and_b32 v32, v50, v2
    v_and_b32 v33, v50, v3
    v_and_b32 v34, v50, v4
    v_and_b32 v35, v50, v5
    s_waitcnt vmcnt(9)
    v_mfma_f32_16x16x32_bf16 v[40:43], v[36:39], v[132:135], v[40:43]
    s_waitcnt lgkmcnt(4)
    v_and_b32 v36, v51, v2
    v_and_b32 v37, v51, v3
    v_and_b32 v38, v51, v4
    v_and_b32 v39, v51, v5
    s_waitcnt vmcnt(8)
    v_mfma_f32_16x16x32_bf16 v[40:43], v[32:35], v[136:139], v[40:43]
    s_waitcnt lgkmcnt(3)
    v_and_b32 v32, v52, v2
    v_and_b32 v33, v52, v3
    v_and_b32 v34, v52, v4
    v_and_b32 v35, v52, v5
    s_waitcnt vmcnt(7)
    v_mfma_f32_16x16x32_bf16 v[40:43], v[36:39], v[140:143], v[40:43]
    s_waitcnt lgkmcnt(2)
    v_and_b32 v36, v53, v2
    v_and_b32 v37, v53, v3
    v_and_b32 v38, v53, v4
    v_and_b32 v39, v53, v5
    s_waitcnt vmcnt(6)
    v_mfma_f32_16x16x32_bf16 v[40:43], v[32:35], v[144:147], v[40:43]
    s_waitcnt lgkmcnt(1)
    v_and_b32 v32, v54, v2
    v_and_b32 v33, v54, v3
    v_and_b32 v34, v54, v4
    v_and_b32 v35, v54, v5
    s_waitcnt vmcnt(5)
    v_mfma_f32_16x16x32_bf16 v[40:43], v[36:39], v[148:151], v[40:43]
    s_waitcnt lgkmcnt(0)
    v_and_b32 v36, v55, v2
    v_and_b32 v37, v55, v3
    v_and_b32 v38, v55, v4
    v_and_b32 v39, v55, v5
    s_waitcnt vmcnt(4)
    v_mfma_f32_16x16x32_bf16 v[40:43], v[32:35], v[152:155], v[40:43]
    v_and_b32 v32, v56, v2
    v_and_b32 v33, v56, v3
    v_and_b32 v34, v56, v4
    v_and_b32 v35, v56, v5
    s_waitcnt vmcnt(3)
    v_mfma_f32_16x16x32_bf16 v[40:43], v[36:39], v[156:159], v[40:43]
    s_waitcnt vmcnt(2)
    v_mfma_f32_16x16x32_bf16 v[40:43], v[32:35], v[160:163], v[40:43]
    s_lshl_b32 s8, s6, 3
    s_add_u32 s8, s8, s3
    s_lshl_b32 s8, s8, 9
    s_add_u32 s8, s8, 1900544
    s_nop 3
    v_permlane32_swap_b32 v40, v42
    v_permlane32_swap_b32 v41, v43
    s_nop 0
    v_add_f32_dpp v40, v42, v40 row_ror:8 row_mask:0xf bank_mask:0xf
    v_add_f32_dpp v41, v43, v41 row_ror:8 row_mask:0xf bank_mask:0xf
    v_bfi_b32 v42, s72, 0, v40
    v_sub_f32 v42, v40, v42
    v_bfi_b32 v43, s72, 0, v41
    v_sub_f32 v43, v41, v43
    v_bfi_b32 v40, s72, v200, v40
    v_bfi_b32 v41, s72, v201, v41
    v_bfi_b32 v42, s72, v200, v42
    v_bfi_b32 v43, s72, v201, v43
    s_mov_b64 exec, s[84:85]
    buffer_store_dwordx2 v[40:41], v203, s[44:47], s8 offen sc1
    buffer_store_dwordx2 v[42:43], v203, s[44:47], s8 offen offset:256 sc1
    s_mov_b64 exec, -1
L_n04:
    s_mov_b32 s64, s34
    s_mov_b32 s65, s35
    s_mov_b32 s66, 1152
    s_mov_b32 s67, 0x20000
    s_mov_b32 s56, s36
    s_mov_b32 s57, s37
    s_mov_b32 s58, 3981312
    s_mov_b32 s59, 0x20000
    s_mul_i32 s12, s3, 18
    s_add_u32 s12, s12, s6
    s_and_b32 s13, s12, 3
    s_lshr_b32 s12, s12, 2
    s_lshl_b32 s8, s13, 3
    s_add_u32 s8, s8, s5
    s_add_u32 s8, s8, 40
    s_lshl_b32 s9, s8, 4
    v_lshrrev_b32 v16, 3, v0
    v_lshlrev_b32 v17, 1, v16
    buffer_load_ushort v62, v17, s[64:67], s9 offen
    s_mul_i32 s8, s8, 55296
    s_lshl_b32 s9, s12, 7
    s_add_u32 s8, s8, s9
    s_add_u32 s8, s8, 2304
    v_mul_u32_u24 v16, 6912, v16
    v_and_b32 v17, 0x70, v1
    v_add_u32 v16, v16, v17
    buffer_load_dwordx4 v[128:131], v16, s[56:59], s8 offen nt
    s_add_u32 s13, s13, 1
    s_mul_i32 s13, s13, 9216
    s_lshl_b32 s12, s12, 8
    s_add_u32 s13, s13, s12
    s_add_u32 s13, s13, 1835008
    s_mul_i32 s8, s5, 272
    v_and_b32 v16, 32, v0
    v_and_b32 v17, 7, v0
    v_lshl_add_u32 v16, v17, 1, v16
    v_bfe_u32 v17, v0, 4, 1
    v_add_lshl_u32 v16, v16, v17, 2
    v_add_u32 v204, s8, v16
    v_add_u32 v211, 64, v204
    v_lshrrev_b32 v16, 3, v0
    v_lshlrev_b32 v16, 15, v16
    v_and_b32 v17, 0x70, v1
    v_add_u32 v12, v16, v17
    s_lshl_b32 s14, s6, 18
    s_lshl_b32 s8, s3, 10
    s_add_u32 s14, s14, s8
    s_lshl_b32 s8, s5, 7
    s_add_u32 s14, s14, s8
    s_cmp_lg_u32 s5, 3
    s_cbranch_scc1 L_tch5
    v_lshlrev_b32 v17, 7, v0
    s_mul_i32 s8, s3, 18
    s_add_u32 s8, s8, s6
    s_lshl_b32 s8, s8, 11
    s_add_u32 s8, s8, 65536
    s_mov_b32 exec_lo, 65535
    s_mov_b32 exec_hi, 0
    buffer_load_dword v205, v17, s[44:47], s8 offen sc1
    s_lshl_b32 s8, s3, 5
    s_add_u32 s8, s8, s4
    s_mul_i32 s8, s8, 1152
    s_add_u32 s8, s8, 458752
    s_mov_b32 exec_lo, 255
    s_mov_b32 exec_hi, 0
    buffer_load_dword v205, v17, s[44:47], s8 offen sc1
    s_mul_i32 s8, s3, 18
    s_add_u32 s8, s8, s6
    s_lshl_b32 s8, s8, 9
    s_add_u32 s8, s8, 1572864
    s_mov_b32 exec_lo, 15
    s_mov_b32 exec_hi, 0
    buffer_load_dword v205, v17, s[44:47], s8 offen sc1
    s_mov_b64 exec, -1
L_tch5:
    s_cmp_eq_u32 s5, 1
    s_cbranch_scc1 L_GU_w1
    s_waitcnt vmcnt(4)
    buffer_load_dwordx4 v[164:167], v12, s[60:63], s14 offen nt
    s_add_u32 s14, s14, 8192
    s_waitcnt vmcnt(4)
    buffer_load_dwordx4 v[168:171], v12, s[60:63], s14 offen nt
    s_add_u32 s14, s14, 8192
    s_waitcnt vmcnt(4)
    buffer_load_dwordx4 v[172:175], v12, s[60:63], s14 offen nt
    s_add_u32 s14, s14, 8192
    s_waitcnt vmcnt(4)
    buffer_load_dwordx4 v[176:179], v12, s[60:63], s14 offen nt
    s_add_u32 s14, s14, 8192
    s_waitcnt vmcnt(4)
    s_waitcnt vmcnt(4)
    v_lshlrev_b32 v62, 16, v62
    v_mul_f32 v33, 0xbfb8aa3b, v62
    v_exp_f32 v33, v33
    s_nop 0
    v_add_f32 v33, 1.0, v33
    v_min_f32 v33, 0x7e800000, v33
    v_rcp_f32 v34, v33
    s_nop 0
    v_mul_f32 v35, v62, v34
    v_fma_f32 v33, -v33, v35, v62
    v_fma_f32 v62, v33, v34, v35
    v_cvt_pk_bf16_f32 v62, v62, v62
    v_and_b32 v52, v62, v2
    v_and_b32 v53, v62, v3
    v_and_b32 v54, v62, v4
    v_and_b32 v55, v62, v5
    s_nop 1
    v_mfma_f32_16x16x32_bf16 v[56:59], v[52:55], v[128:131], 0
    s_nop 7
    v_permlane32_swap_b32 v56, v58
    v_permlane32_swap_b32 v57, v59
    s_nop 0
    v_add_f32_dpp v56, v58, v56 row_ror:8 row_mask:0xf bank_mask:0xf
    v_add_f32_dpp v57, v59, v57 row_ror:8 row_mask:0xf bank_mask:0xf
    s_mov_b64 exec, s[84:85]
    ds_write_b32 v204, v56 offset:2304
    ds_write_b32 v211, v57 offset:2304
    s_mov_b64 exec, -1
    s_cmp_lg_u32 s5, 2
    s_cbranch_scc1 L_nc6
    s_lshl_b32 s10, s3, 9
    s_add_u32 s10, s10, 1015808
    v_and_b32 v16, 0x1f0, v1
    buffer_load_dwordx4 v[44:47], v16, s[44:47], s10 offen sc1
L_nc6:
    s_add_u32 s77, s94, 737280
    s_and_b32 s77, s77, 0xfffff
    buffer_load_dwordx4 v[72:75], v14, s[48:51], s77 offen nt
    s_waitcnt vmcnt(4)
    s_add_u32 s77, s94, 1105920
    s_and_b32 s77, s77, 0xfffff
    buffer_load_dwordx4 v[76:79], v14, s[48:51], s77 offen nt
    s_cmp_lg_u32 s5, 2
    s_cbranch_scc1 L_GU_b1
    s_waitcnt vmcnt(2)
    v_readfirstlane_b32 s10, v44
    v_xor_b32 v17, v44, v6
    v_bitop3_b32 v17, v45, v7, v17 bitop3:0xbe
    v_bitop3_b32 v17, v46, v8, v17 bitop3:0xbe
    v_bitop3_b32 v17, v47, v9, v17 bitop3:0xbe
    v_and_b32 v17, s72, v17
    v_xor_b32 v18, s10, v44
    v_or_b32 v17, v17, v18
    v_cmp_ne_u32 vcc, 0, v17
    s_cmp_eq_u64 vcc, 0
    s_cselect_b32 s10, 1, 0
    v_mov_b32 v44, s10
    v_mov_b32 v45, 0
    ds_write_b32 v45, v44 offset:4992
    s_branch L_GU_b1
L_GU_w1:
    buffer_load_dwordx4 v[164:167], v12, s[60:63], s14 offen nt
    s_add_u32 s14, s14, 8192
    buffer_load_dwordx4 v[168:171], v12, s[60:63], s14 offen nt
    s_add_u32 s14, s14, 8192
    buffer_load_dwordx4 v[172:175], v12, s[60:63], s14 offen nt
    s_add_u32 s14, s14, 8192
    buffer_load_dwordx4 v[176:179], v12, s[60:63], s14 offen nt
    s_add_u32 s14, s14, 8192
    s_waitcnt vmcnt(4)
    v_mov_b32 v41, 0x3f803f80
    v_mov_b32 v42, 0
    v_mov_b32 v43, 0
    v_dot2_f32_bf16 v42, v32, v41, v42
    v_dot2_f32_bf16 v42, v33, v41, v42
    v_dot2_f32_bf16 v42, v34, v41, v42
    v_dot2_f32_bf16 v42, v35, v41, v42
    v_dot2_f32_bf16 v42, v36, v41, v42
    v_dot2_f32_bf16 v42, v37, v41, v42
    v_dot2_f32_bf16 v42, v38, v41, v42
    v_dot2_f32_bf16 v42, v39, v41, v42
    v_dot2_f32_bf16 v43, v32, v32, v43
    v_dot2_f32_bf16 v43, v33, v33, v43
    v_dot2_f32_bf16 v43, v34, v34, v43
    v_dot2_f32_bf16 v43, v35, v35, v43
    v_dot2_f32_bf16 v43, v36, v36, v43
    v_dot2_f32_bf16 v43, v37, v37, v43
    v_dot2_f32_bf16 v43, v38, v38, v43
    v_dot2_f32_bf16 v43, v39, v39, v43
    s_nop 2
    v_permlane32_swap_b32 v42, v43
    v_add_f32 v42, v42, v43
    v_mov_b32 v43, v42
    s_nop 1
    v_permlane16_swap_b32 v42, v43
    v_add_f32 v42, v42, v43
    s_nop 1
    v_add_f32_dpp v42, v42, v42 row_ror:8 row_mask:0xf bank_mask:0xf
    s_nop 1
    v_add_f32_dpp v42, v42, v42 row_ror:4 row_mask:0xf bank_mask:0xf
    s_nop 1
    v_add_f32_dpp v42, v42, v42 row_ror:2 row_mask:0xf bank_mask:0xf
    s_nop 1
    v_add_f32_dpp v42, v42, v42 row_ror:1 row_mask:0xf bank_mask:0xf
    v_mov_b32 v43, v42
    s_nop 1
    v_permlane32_swap_b32 v42, v43
    v_mul_f32 v42, 0x3ae38e39, v42
    v_mul_f32 v43, 0x3ae38e39, v43
    v_fma_f32 v43, -v42, v42, v43
    v_max_f32 v43, 0, v43
    v_cvt_pk_bf16_f32 v45, v42, v43
    v_lshlrev_b32 v44, 16, v45
    v_and_b32 v43, s73, v45
    v_add_f32 v43, 0x3727c5ac, v43
    v_cvt_pk_bf16_f32 v43, v43, v43
    v_and_b32 v43, s73, v43
    v_sqrt_f32 v43, v43
    s_nop 0
    v_cvt_pk_bf16_f32 v43, v43, v43
    v_and_b32 v43, s73, v43
    v_lshlrev_b32 v40, 16, v40
    v_sub_f32 v40, v40, v44
    v_cvt_pk_bf16_f32 v40, v40, v40
    v_and_b32 v40, s73, v40
    v_min_f32 v43, 0x7e800000, v43
    v_rcp_f32 v45, v43
    s_nop 0
    v_mul_f32 v46, v40, v45
    v_fma_f32 v43, -v43, v46, v40
    v_fma_f32 v40, v43, v45, v46
    v_cvt_pk_bf16_f32 v40, v40, v40
    v_and_b32 v40, s73, v40
    v_lshlrev_b32 v28, 2, v28
    v_lshlrev_b32 v62, 16, v62
    v_mul_f32 v33, 0xbfb8aa3b, v62
    v_exp_f32 v33, v33
    s_nop 0
    v_add_f32 v33, 1.0, v33
    v_min_f32 v33, 0x7e800000, v33
    v_rcp_f32 v34, v33
    s_nop 0
    v_mul_f32 v35, v62, v34
    v_fma_f32 v33, -v33, v35, v62
    v_fma_f32 v62, v33, v34, v35
    v_cvt_pk_bf16_f32 v62, v62, v62
    v_and_b32 v52, v62, v2
    v_and_b32 v53, v62, v3
    v_and_b32 v54, v62, v4
    v_and_b32 v55, v62, v5
    s_nop 1
    v_mfma_f32_16x16x32_bf16 v[56:59], v[52:55], v[128:131], 0
    s_nop 7
    v_permlane32_swap_b32 v56, v58
    v_permlane32_swap_b32 v57, v59
    s_nop 0
    v_add_f32_dpp v56, v58, v56 row_ror:8 row_mask:0xf bank_mask:0xf
    v_add_f32_dpp v57, v59, v57 row_ror:8 row_mask:0xf bank_mask:0xf
    s_mov_b64 exec, s[84:85]
    ds_write_b32 v204, v56 offset:2304
    ds_write_b32 v211, v57 offset:2304
    s_mov_b64 exec, -1
    v_lshrrev_b32 v16, 3, v0
    v_lshlrev_b32 v16, 9, v16
    v_and_b32 v17, 0x70, v1
    v_add_u32 v26, v16, v17
    s_lshr_b32 s8, s6, 1
    s_lshl_b32 s8, s8, 12
    s_and_b32 s9, s6, 1
    s_lshl_b32 s9, s9, 7
    s_add_u32 s8, s8, s9
    s_add_u32 s8, s8, 1900544
    s_add_u32 s9, s8, 36864
    s_add_u32 s77, s94, 737280
    s_and_b32 s77, s77, 0xfffff
    buffer_load_dwordx4 v[72:75], v14, s[48:51], s77 offen nt
    s_waitcnt vmcnt(4)
    s_add_u32 s77, s94, 1105920
    s_and_b32 s77, s77, 0xfffff
    buffer_load_dwordx4 v[76:79], v14, s[48:51], s77 offen nt
    s_waitcnt vmcnt(4)
    s_mov_b32 s7, 0
L_poll7:
    buffer_load_dwordx4 v[32:35], v26, s[44:47], s8 offen sc1
    buffer_load_dwordx4 v[36:39], v26, s[44:47], s9 offen sc1
    buffer_load_dwordx4 v[44:47], v26, s[44:47], s8 offen offset:256 sc1
    buffer_load_dwordx4 v[48:51], v26, s[44:47], s9 offen offset:256 sc1
    s_add_u32 s7, s7, 1
    s_cmp_gt_u32 s7, 400000
    s_cbranch_scc1 L_end
    s_waitcnt vmcnt(0)
    v_xor_b32 v32, v32, v6
    v_xor_b32 v33, v33, v7
    v_xor_b32 v34, v34, v8
    v_xor_b32 v35, v35, v9
    v_xor_b32 v36, v36, v6
    v_xor_b32 v37, v37, v7
    v_xor_b32 v38, v38, v8
    v_xor_b32 v39, v39, v9
    v_xor_b32 v44, v44, v6
    v_xor_b32 v45, v45, v7
    v_xor_b32 v46, v46, v8
    v_xor_b32 v47, v47, v9
    v_xor_b32 v48, v48, v6
    v_xor_b32 v49, v49, v7
    v_xor_b32 v50, v50, v8
    v_xor_b32 v51, v51, v9
    v_or3_b32 v236, v32, v33, v34
    v_or3_b32 v237, v35, v36, v37
    v_or3_b32 v238, v38, v39, v44
    v_or3_b32 v239, v45, v46, v47
    v_or3_b32 v240, v48, v49, v50
    v_or3_b32 v241, v51, v236, v237
    v_or3_b32 v242, v238, v239, v240
    v_bitop3_b32 v21, v241, v242, s72 bitop3:0xa8
    v_cmp_ne_u32 vcc, 0, v21
    s_cbranch_vccnz L_poll7
    v_pk_add_f32 v[32:33], v[32:33], v[44:45]
    v_pk_add_f32 v[34:35], v[34:35], v[46:47]
    v_pk_add_f32 v[36:37], v[36:37], v[48:49]
    v_pk_add_f32 v[38:39], v[38:39], v[50:51]
    v_permlane32_swap_b32 v32, v34
    v_permlane32_swap_b32 v33, v35
    v_add_f32 v32, v32, v34
    v_add_f32 v33, v33, v35
    s_nop 1
    v_permlane16_swap_b32 v32, v33
    v_add_f32 v32, v32, v33
    v_permlane32_swap_b32 v36, v38
    v_permlane32_swap_b32 v37, v39
    v_add_f32 v36, v36, v38
    v_add_f32 v37, v37, v39
    s_nop 1
    v_permlane16_swap_b32 v36, v37
    v_add_f32 v36, v36, v37
    v_add_f32_dpp v32, v32, v32 row_ror:8 row_mask:0xf bank_mask:0xf
    s_nop 0
    v_add_f32_dpp v36, v36, v36 row_ror:8 row_mask:0xf bank_mask:0xf
    v_cvt_pk_bf16_f32 v33, v32, v36
    v_lshlrev_b32 v32, 16, v33
    v_and_b32 v36, s73, v33
    v_add_f32 v36, 1.0, v36
    v_cvt_pk_bf16_f32 v36, v36, v36
    v_and_b32 v36, s73, v36
    v_mul_f32 v36, v36, v40
    v_cvt_pk_bf16_f32 v36, v36, v36
    v_and_b32 v36, s73, v36
    v_add_f32 v36, v36, v32
    v_cvt_pk_bf16_f32 v36, v36, v36
    ds_write_b32 v28, v36 offset:4864
L_GU_b1:
    v_lshrrev_b32 v25, 3, v0
    v_lshlrev_b32 v26, 4, v25
    v_mov_b32 v27, 0
    v_and_b32 v16, 7, v0
    v_and_b32 v17, 0x30, v0
    v_lshrrev_b32 v17, 1, v17
    v_add_lshl_u32 v24, v16, v17, 3
    s_mul_i32 s9, s3, 18
    s_add_u32 s9, s9, s6
    s_lshl_b32 s9, s9, 11
    s_add_u32 s9, s9, 65536
    s_lshl_b32 s10, s5, 8
    s_add_u32 s9, s9, s10
    s_waitcnt lgkmcnt(0)
    s_barrier
    ds_read_b128 v[48:51], v26 offset:4864
    ds_read_b32 v52, v27 offset:4992
    s_waitcnt lgkmcnt(0)
    v_readfirstlane_b32 s74, v52
    s_waitcnt vmcnt(2)
    v_and_b32 v32, v48, v2
    v_and_b32 v33, v48, v3
    v_and_b32 v34, v48, v4
    v_and_b32 v35, v48, v5
    v_and_b32 v36, v49, v2
    v_and_b32 v37, v49, v3
    v_and_b32 v38, v49, v4
    v_and_b32 v39, v49, v5
    v_mfma_f32_16x16x32_bf16 v[40:43], v[32:35], v[164:167], 0
    v_and_b32 v32, v50, v2
    v_and_b32 v33, v50, v3
    v_and_b32 v34, v50, v4
    v_and_b32 v35, v50, v5
    v_mfma_f32_16x16x32_bf16 v[40:43], v[36:39], v[168:171], v[40:43]
    v_and_b32 v36, v51, v2
    v_and_b32 v37, v51, v3
    v_and_b32 v38, v51, v4
    v_and_b32 v39, v51, v5
    v_mfma_f32_16x16x32_bf16 v[40:43], v[32:35], v[172:175], v[40:43]
    s_nop 0
    v_mfma_f32_16x16x32_bf16 v[40:43], v[36:39], v[176:179], v[40:43]
    s_nop 7
    v_permlane32_swap_b32 v40, v42
    v_permlane32_swap_b32 v41, v43
    s_nop 0
    v_add_f32_dpp v40, v42, v40 row_ror:8 row_mask:0xf bank_mask:0xf
    v_add_f32_dpp v41, v43, v41 row_ror:8 row_mask:0xf bank_mask:0xf
    v_add_u32 v40, 0x200, v40
    v_add_u32 v41, 0x200, v41
    v_bfi_b32 v40, s72, v10, v40
    v_bfi_b32 v41, s72, v11, v41
    s_mov_b64 exec, s[84:85]
    s_cmp_eq_u32 s74, 0
    s_cbranch_scc1 L_ls8
    buffer_store_dwordx2 v[40:41], v24, s[44:47], s9 offen
    s_branch L_le9
L_ls8:
    buffer_store_dwordx2 v[40:41], v24, s[44:47], s9 offen sc1
L_le9:
    s_mov_b64 exec, -1
    s_cmp_lg_u32 s5, 0
    s_cbranch_scc1 L_ap10
    ds_read_b128 v[16:19], v208 offset:2304
    ds_read_b128 v[20:23], v208 offset:3392
    s_waitcnt lgkmcnt(0)
    v_pk_add_f32 v[16:17], v[16:17], v[20:21]
    v_pk_add_f32 v[18:19], v[18:19], v[22:23]
    s_nop 1
    v_permlane32_swap_b32 v16, v18
    v_permlane32_swap_b32 v17, v19
    v_pk_add_f32 v[16:17], v[16:17], v[18:19]
    s_nop 1
    v_permlane16_swap_b32 v16, v17
    v_add_f32 v16, v16, v17
    v_bfi_b32 v16, s72, v216, v16
    buffer_store_dword v16, v234, s[44:47], s13 offen sc1
L_ap10:
L_GU_b2:
    s_barrier
    s_add_u32 s77, s94, 1474560
    s_and_b32 s77, s77, 0xfffff
    buffer_load_dwordx4 v[80:83], v14, s[48:51], s77 offen nt
    s_add_u32 s77, s94, 1843200
    s_and_b32 s77, s77, 0xfffff
    buffer_load_dwordx4 v[84:87], v14, s[48:51], s77 offen nt
    s_add_u32 s77, s94, 2211840
    s_and_b32 s77, s77, 0xfffff
    buffer_load_dwordx4 v[88:91], v14, s[48:51], s77 offen nt
    s_add_u32 s77, s94, 2580480
    s_and_b32 s77, s77, 0xfffff
    buffer_load_dwordx4 v[92:95], v14, s[48:51], s77 offen nt
    s_mul_i32 s8, s5, 272
    v_and_b32 v16, 1, v0
    v_lshlrev_b32 v16, 5, v16
    v_and_b32 v17, 16, v0
    v_lshrrev_b32 v18, 5, v0
    v_lshlrev_b32 v18, 3, v18
    v_add3_u32 v16, v16, v17, v18
    v_bfe_u32 v17, v0, 1, 2
    v_add_lshl_u32 v16, v16, v17, 2
    v_add_u32 v204, s8, v16
    v_add_u32 v211, 16, v204
    s_add_u32 s15, s6, 2
    s_cmp_ge_u32 s15, 18
    s_cselect_b32 s8, 18, 0
    s_sub_u32 s15, s15, s8
    s_cmp_ge_u32 s5, 99
    s_cselect_b32 s9, s15, s6
    s_cmp_ge_u32 s9, 9
    s_cselect_b32 s60, s30, s28
    s_cselect_b32 s61, s31, s29
    s_cselect_b32 s8, 9, 0
    s_mov_b32 s62, 5308416
    s_sub_u32 s8, s9, s8
    s_lshl_b32 s8, s8, 7
    s_mul_i32 s14, s3, 1152
    s_add_u32 s14, s14, s8
    s_mul_i32 s8, s5, 663552
    s_add_u32 s14, s14, s8
    v_lshrrev_b32 v16, 3, v0
    v_and_b32 v17, 0x70, v1
    v_mul_u32_u24 v16, 9216, v16
    v_lshl_add_u32 v12, v16, 3, v17
    v_add_u32 v16, 516096, v16
    v_add_u32 v13, v16, v17
    s_mul_i32 s9, s3, 36864
    s_lshr_b32 s10, s4, 4
    s_lshl_b32 s10, s10, 10
    s_add_u32 s9, s9, s10
    s_lshl_b32 s10, s5, 7
    s_add_u32 s9, s9, s10
    s_add_u32 s9, s9, 65536
    s_add_u32 s11, s9, 16384
    s_add_u32 s64, s9, 32768
    v_lshrrev_b32 v16, 3, v0
    v_lshlrev_b32 v16, 11, v16
    v_and_b32 v17, 0x70, v1
    v_add_u32 v28, v16, v17
    v_and_b32 v16, 3, v0
    v_lshlrev_b32 v16, 4, v16
    v_and_b32 v17, 4, v0
    v_lshrrev_b32 v18, 5, v0
    v_lshlrev_b32 v18, 3, v18
    v_add3_u32 v16, v16, v17, v18
    v_bfe_u32 v17, v0, 4, 1
    s_lshr_b32 s10, s5, 1
    s_lshl_b32 s10, s10, 6
    s_and_b32 s8, s5, 1
    s_lshl_b32 s8, s8, 1
    s_add_u32 s10, s10, s8
    v_add3_u32 v16, v16, v17, s10
    v_lshlrev_b32 v26, 1, v16
    v_and_b32 v16, 8, v0
    v_lshlrev_b32 v29, 2, v16
    v_lshlrev_b32 v16, 5, v16
    v_and_b32 v18, 3, v0
    v_lshlrev_b32 v18, 6, v18
    v_and_b32 v17, 0x30, v0
    v_add3_u32 v27, v16, v17, v18
    s_lshl_b32 s8, s5, 2
    v_add_u32 v30, s8, v29
    v_and_b32 v16, 32, v0
    v_lshlrev_b32 v16, 2, v16
    v_and_b32 v17, 12, v0
    v_lshlrev_b32 v17, 3, v17
    v_and_b32 v18, 19, v0
    v_add3_u32 v22, v16, v17, v18
    s_mul_i32 s8, s5, 1152
    s_add_u32 s10, s8, 5120
    v_lshl_add_u32 v22, v22, 2, s10
    v_and_b32 v16, 8, v0
    v_add_u32 v31, s8, v16
    v_lshrrev_b32 v16, 3, v0
    v_mul_u32_u24 v24, 1152, v16
    v_and_b32 v17, 0x70, v1
    s_lshl_b32 s8, s5, 7
    v_add3_u32 v23, v24, v17, s8
    v_and_b32 v16, 0x30, v0
    v_lshrrev_b32 v19, 2, v16
    v_lshrrev_b32 v17, 2, v17
    v_lshl_add_u32 v20, v16, 1, v17
    s_lshl_b32 s12, s3, 5
    s_add_u32 s12, s12, s4
    s_mul_i32 s12, s12, 1152
    s_add_u32 s12, s12, 458752
    s_add_u32 s13, s12, s8
    s_lshl_b32 s10, s3, 9
    s_add_u32 s10, s10, 1015808
    v_and_b32 v16, 0x1f0, v1
    buffer_load_dwordx4 v[40:43], v16, s[44:47], s10 offen sc1
    v_mov_b32 v44, v6
    v_mov_b32 v45, v7
    v_mov_b32 v46, v8
    v_mov_b32 v47, v9
    buffer_load_dwordx4 v[32:35], v28, s[44:47], s9 offen sc1
    buffer_load_dwordx4 v[36:39], v28, s[44:47], s11 offen sc1
    s_mov_b64 exec, 0xffff
    buffer_load_dwordx4 v[44:47], v28, s[44:47], s64 offen sc1
    s_mov_b64 exec, -1
    s_add_u32 s77, s94, 0
    s_and_b32 s77, s77, 0xfffff
    buffer_load_dwordx4 v[96:99], v210, s[52:55], s77 offen nt
    s_waitcnt vmcnt(8)
    s_add_u32 s77, s94, 368640
    s_and_b32 s77, s77, 0xfffff
    buffer_load_dwordx4 v[100:103], v210, s[52:55], s77 offen nt
    s_waitcnt vmcnt(8)
    s_add_u32 s77, s94, 737280
    s_and_b32 s77, s77, 0xfffff
    buffer_load_dwordx4 v[104:107], v210, s[52:55], s77 offen nt
    s_waitcnt vmcnt(8)
    s_add_u32 s77, s94, 1105920
    s_and_b32 s77, s77, 0xfffff
    buffer_load_dwordx4 v[108:111], v210, s[52:55], s77 offen nt
    s_waitcnt vmcnt(4)
    v_readfirstlane_b32 s10, v40
    v_xor_b32 v17, v40, v6
    v_bitop3_b32 v17, v41, v7, v17 bitop3:0xbe
    v_bitop3_b32 v17, v42, v8, v17 bitop3:0xbe
    v_bitop3_b32 v17, v43, v9, v17 bitop3:0xbe
    v_and_b32 v17, s72, v17
    v_xor_b32 v18, s10, v40
    v_or_b32 v17, v17, v18
    v_cmp_ne_u32 vcc, 0, v17
    s_cmp_eq_u64 vcc, 0
    s_cselect_b32 s74, 1, 0
    v_xor_b32 v32, v32, v6
    v_xor_b32 v33, v33, v7
    v_xor_b32 v34, v34, v8
    v_xor_b32 v35, v35, v9
    v_xor_b32 v36, v36, v6
    v_xor_b32 v37, v37, v7
    v_xor_b32 v38, v38, v8
    v_xor_b32 v39, v39, v9
    v_xor_b32 v44, v44, v6
    v_xor_b32 v45, v45, v7
    v_xor_b32 v46, v46, v8
    v_xor_b32 v47, v47, v9
    v_or3_b32 v236, v32, v33, v34
    v_or3_b32 v237, v35, v36, v37
    v_or3_b32 v238, v38, v39, v44
    v_or3_b32 v239, v45, v46, v47
    v_or3_b32 v240, v236, v237, v238
    v_bitop3_b32 v21, v239, v240, s72 bitop3:0xa8
    v_cmp_ne_u32 vcc, 0, v21
    s_cbranch_vccz L_qok11
    s_mov_b32 s7, 0
L_poll12:
    v_mov_b32 v44, v6
    v_mov_b32 v45, v7
    v_mov_b32 v46, v8
    v_mov_b32 v47, v9
    buffer_load_dwordx4 v[32:35], v28, s[44:47], s9 offen sc1
    buffer_load_dwordx4 v[36:39], v28, s[44:47], s11 offen sc1
    s_mov_b64 exec, 0xffff
    buffer_load_dwordx4 v[44:47], v28, s[44:47], s64 offen sc1
    s_mov_b64 exec, -1
    s_add_u32 s7, s7, 1
    s_cmp_gt_u32 s7, 400000
    s_cbranch_scc1 L_end
    s_waitcnt vmcnt(0)
    v_xor_b32 v32, v32, v6
    v_xor_b32 v33, v33, v7
    v_xor_b32 v34, v34, v8
    v_xor_b32 v35, v35, v9
    v_xor_b32 v36, v36, v6
    v_xor_b32 v37, v37, v7
    v_xor_b32 v38, v38, v8
    v_xor_b32 v39, v39, v9
    v_xor_b32 v44, v44, v6
    v_xor_b32 v45, v45, v7
    v_xor_b32 v46, v46, v8
    v_xor_b32 v47, v47, v9
    v_or3_b32 v236, v32, v33, v34
    v_or3_b32 v237, v35, v36, v37
    v_or3_b32 v238, v38, v39, v44
    v_or3_b32 v239, v45, v46, v47
    v_or3_b32 v240, v236, v237, v238
    v_bitop3_b32 v21, v239, v240, s72 bitop3:0xa8
    v_cmp_ne_u32 vcc, 0, v21
    s_cbranch_vccnz L_poll12
L_qok11:
    s_waitcnt vmcnt(8)
    s_add_u32 s77, s94, 1474560
    s_and_b32 s77, s77, 0xfffff
    buffer_load_dwordx4 v[112:115], v210, s[52:55], s77 offen nt
    v_pk_add_f32 v[32:33], v[32:33], v[44:45]
    v_pk_add_f32 v[34:35], v[34:35], v[46:47]
    v_pk_add_f32 v[32:33], v[32:33], v[36:37]
    v_pk_add_f32 v[34:35], v[34:35], v[38:39]
    s_nop 1
    v_permlane32_swap_b32 v32, v34
    v_permlane32_swap_b32 v33, v35
    v_pk_add_f32 v[32:33], v[32:33], v[34:35]
    s_nop 1
    v_permlane16_swap_b32 v32, v33
    v_add_f32 v32, v32, v33
    s_nop 1
    v_add_f32_dpp v32, v32, v32 row_ror:8 row_mask:0xf bank_mask:0xf
    v_cvt_pk_bf16_f32 v32, v32, v32
    ds_write_b16 v26, v32 offset:14336
    s_waitcnt lgkmcnt(0)
    s_barrier
    ds_read_b128 v[32:35], v27 offset:14336
    s_add_u32 s77, s94, 1843200
    s_and_b32 s77, s77, 0xfffff
    buffer_load_dwordx4 v[116:119], v210, s[52:55], s77 offen nt
    s_add_u32 s77, s94, 2211840
    s_and_b32 s77, s77, 0xfffff
    buffer_load_dwordx4 v[120:123], v210, s[52:55], s77 offen nt
    s_add_u32 s77, s94, 2580480
    s_and_b32 s77, s77, 0xfffff
    buffer_load_dwordx4 v[124:127], v210, s[52:55], s77 offen nt
    s_waitcnt lgkmcnt(0)
    v_cndmask_b32 v36, v32, 0, s[86:87]
    v_cndmask_b32 v37, v33, 0, s[86:87]
    v_cndmask_b32 v38, v34, 0, s[86:87]
    v_cndmask_b32 v39, v35, 0, s[86:87]
    v_cndmask_b32 v32, 0, v32, s[86:87]
    v_cndmask_b32 v33, 0, v33, s[86:87]
    v_cndmask_b32 v34, 0, v34, s[86:87]
    v_cndmask_b32 v35, 0, v35, s[86:87]
    v_mfma_f32_16x16x32_bf16 v[40:43], v[68:71], v[36:39], 0
    v_mfma_f32_16x16x32_bf16 v[44:47], v[76:79], v[36:39], 0
    v_mfma_f32_16x16x32_bf16 v[48:51], v[84:87], v[36:39], 0
    v_mfma_f32_16x16x32_bf16 v[52:55], v[92:95], v[36:39], 0
    v_mfma_f32_16x16x32_bf16 v[40:43], v[64:67], v[32:35], v[40:43]
    v_mfma_f32_16x16x32_bf16 v[44:47], v[72:75], v[32:35], v[44:47]
    v_mfma_f32_16x16x32_bf16 v[48:51], v[80:83], v[32:35], v[48:51]
    v_mfma_f32_16x16x32_bf16 v[52:55], v[88:91], v[32:35], v[52:55]
    s_lshl_b32 s12, s3, 5
    s_add_u32 s12, s12, s4
    s_lshl_b32 s12, s12, 4
    s_add_u32 s12, s12, 1024000
    s_lshl_b32 s8, s5, 3
    s_mov_b32 s10, 0x00010001
    s_mov_b32 s11, 0x00010001
    v_mov_b32_dpp v56, v40 quad_perm:[0,0,0,0] row_mask:0xf bank_mask:0xf
    v_add_f32_dpp v56, v41, v56 quad_perm:[1,1,1,1] row_mask:0xf bank_mask:0xf
    v_add_f32_dpp v56, v42, v56 quad_perm:[2,2,2,2] row_mask:0xf bank_mask:0xf
    v_add_f32_dpp v56, v43, v56 quad_perm:[3,3,3,3] row_mask:0xf bank_mask:0xf
    v_mov_b32_dpp v57, v44 quad_perm:[0,0,0,0] row_mask:0xf bank_mask:0xf
    v_add_f32_dpp v57, v45, v57 quad_perm:[1,1,1,1] row_mask:0xf bank_mask:0xf
    v_add_f32_dpp v57, v46, v57 quad_perm:[2,2,2,2] row_mask:0xf bank_mask:0xf
    v_add_f32_dpp v57, v47, v57 quad_perm:[3,3,3,3] row_mask:0xf bank_mask:0xf
    v_mov_b32_dpp v58, v48 quad_perm:[0,0,0,0] row_mask:0xf bank_mask:0xf
    v_add_f32_dpp v58, v49, v58 quad_perm:[1,1,1,1] row_mask:0xf bank_mask:0xf
    v_add_f32_dpp v58, v50, v58 quad_perm:[2,2,2,2] row_mask:0xf bank_mask:0xf
    v_add_f32_dpp v58, v51, v58 quad_perm:[3,3,3,3] row_mask:0xf bank_mask:0xf
    v_mov_b32_dpp v59, v52 quad_perm:[0,0,0,0] row_mask:0xf bank_mask:0xf
    v_add_f32_dpp v59, v53, v59 quad_perm:[1,1,1,1] row_mask:0xf bank_mask:0xf
    v_add_f32_dpp v59, v54, v59 quad_perm:[2,2,2,2] row_mask:0xf bank_mask:0xf
    v_add_f32_dpp v59, v55, v59 quad_perm:[3,3,3,3] row_mask:0xf bank_mask:0xf
    v_cvt_pk_bf16_f32 v60, v56, v57
    v_lshlrev_b32 v56, 16, v60
    v_and_b32 v57, s73, v60
    v_cvt_pk_bf16_f32 v61, v58, v59
    v_lshlrev_b32 v58, 16, v61
    v_and_b32 v59, s73, v61
    v_mul_f32 v56, 0x3db504f3, v56
    v_mul_f32 v57, 0x3db504f3, v57
    v_mul_f32 v58, 0x3db504f3, v58
    v_mul_f32 v59, 0x3db504f3, v59
    v_cvt_pk_bf16_f32 v60, v56, v57
    v_lshlrev_b32 v56, 16, v60
    v_and_b32 v57, s73, v60
    v_cvt_pk_bf16_f32 v61, v58, v59
    v_lshlrev_b32 v58, 16, v61
    v_and_b32 v59, s73, v61
    v_max3_f32 v60, v56, v57, v58
    v_max_f32 v60, v60, v59
    s_nop 1
    v_max_f32_dpp v60, v60, v60 row_half_mirror row_mask:0xf bank_mask:0xf
    v_mov_b32 v61, v60
    s_nop 1
    v_permlane16_swap_b32 v60, v61
    v_max_f32 v60, v60, v61
    v_mov_b32 v61, v60
    s_nop 1
    v_permlane32_swap_b32 v60, v61
    v_max_f32 v60, v60, v61
    buffer_load_dwordx4 v[164:167], v12, s[60:63], s14 offen nt
    s_add_u32 s14, s14, 9216
    buffer_load_dwordx4 v[168:171], v12, s[60:63], s14 offen nt
    s_add_u32 s14, s14, 9216
    v_sub_f32 v56, v56, v60
    v_sub_f32 v57, v57, v60
    v_sub_f32 v58, v58, v60
    v_sub_f32 v59, v59, v60
    v_mul_f32 v56, s76, v56
    v_mul_f32 v57, s76, v57
    v_mul_f32 v58, s76, v58
    v_mul_f32 v59, s76, v59
    v_exp_f32 v56, v56
    v_exp_f32 v57, v57
    v_exp_f32 v58, v58
    v_exp_f32 v59, v59
    v_cvt_pk_bf16_f32 v56, v56, v56
    v_cvt_pk_bf16_f32 v57, v57, v57
    v_cvt_pk_bf16_f32 v58, v58, v58
    v_cvt_pk_bf16_f32 v59, v59, v59
    v_and_b32 v44, s73, v56
    v_and_b32 v45, s73, v57
    v_and_b32 v46, s73, v58
    v_and_b32 v47, s73, v59
    v_add_f32 v44, v44, v45
    v_add_f32 v46, v46, v47
    v_add_f32 v61, v44, v46
    v_and_b32 v64, v56, v2
    v_and_b32 v65, v56, v3
    v_and_b32_dpp v66, v56, v4 row_shr:4 row_mask:0xf bank_mask:0xf bound_ctrl:0
    v_and_b32_dpp v67, v56, v5 row_shr:4 row_mask:0xf bank_mask:0xf bound_ctrl:0
    v_add_f32_dpp v61, v61, v61 row_half_mirror row_mask:0xf bank_mask:0xf
    v_mov_b32 v44, v61
    v_and_b32_dpp v68, v56, v2 row_shl:4 row_mask:0xf bank_mask:0xf bound_ctrl:0
    v_and_b32_dpp v69, v56, v3 row_shl:4 row_mask:0xf bank_mask:0xf bound_ctrl:0
    v_and_b32 v70, v56, v4
    v_and_b32 v71, v56, v5
    v_permlane16_swap_b32 v61, v44
    v_add_f32 v61, v61, v44
    v_mov_b32 v44, v61
    v_and_b32 v72, v57, v2
    v_and_b32 v73, v57, v3
    v_and_b32_dpp v74, v57, v4 row_shr:4 row_mask:0xf bank_mask:0xf bound_ctrl:0
    v_and_b32_dpp v75, v57, v5 row_shr:4 row_mask:0xf bank_mask:0xf bound_ctrl:0
    v_permlane32_swap_b32 v61, v44
    v_add_f32 v61, v61, v44
    s_mov_b64 exec, 0x101
    ds_write_b64 v31, v[60:61] offset:6144
    s_mov_b64 exec, -1
    v_and_b32_dpp v76, v57, v2 row_shl:4 row_mask:0xf bank_mask:0xf bound_ctrl:0
    v_and_b32_dpp v77, v57, v3 row_shl:4 row_mask:0xf bank_mask:0xf bound_ctrl:0
    v_and_b32 v78, v57, v4
    v_and_b32 v79, v57, v5
    v_and_b32 v80, v58, v2
    v_and_b32 v81, v58, v3
    v_and_b32_dpp v82, v58, v4 row_shr:4 row_mask:0xf bank_mask:0xf bound_ctrl:0
    v_and_b32_dpp v83, v58, v5 row_shr:4 row_mask:0xf bank_mask:0xf bound_ctrl:0
    v_and_b32_dpp v84, v58, v2 row_shl:4 row_mask:0xf bank_mask:0xf bound_ctrl:0
    v_and_b32_dpp v85, v58, v3 row_shl:4 row_mask:0xf bank_mask:0xf bound_ctrl:0
    v_and_b32 v86, v58, v4
    v_and_b32 v87, v58, v5
    v_and_b32 v88, v59, v2
    v_and_b32 v89, v59, v3
    v_and_b32_dpp v90, v59, v4 row_shr:4 row_mask:0xf bank_mask:0xf bound_ctrl:0
    v_and_b32_dpp v91, v59, v5 row_shr:4 row_mask:0xf bank_mask:0xf bound_ctrl:0
    v_and_b32_dpp v92, v59, v2 row_shl:4 row_mask:0xf bank_mask:0xf bound_ctrl:0
    v_and_b32_dpp v93, v59, v3 row_shl:4 row_mask:0xf bank_mask:0xf bound_ctrl:0
    v_and_b32 v94, v59, v4
    v_and_b32 v95, v59, v5
    s_waitcnt lgkmcnt(0)
    s_barrier
    ds_read_b128 v[44:47], v24 offset:6144
    s_waitcnt vmcnt(9)
    v_mfma_f32_16x16x32_bf16 v[40:43], v[64:67], v[96:99], 0
    s_waitcnt vmcnt(8)
    v_mfma_f32_16x16x32_bf16 v[40:43], v[68:71], v[100:103], v[40:43]
    s_waitcnt vmcnt(7)
    v_mfma_f32_16x16x32_bf16 v[40:43], v[72:75], v[104:107], v[40:43]
    s_waitcnt lgkmcnt(0)
    v_max_f32_dpp v48, v44, v44 row_ror:8 row_mask:0xf bank_mask:0xf
    v_max_f32_dpp v50, v46, v46 row_ror:8 row_mask:0xf bank_mask:0xf
    v_mov_b32 v49, v48
    v_mov_b32 v51, v50
    s_nop 0
    v_permlane16_swap_b32 v48, v49
    v_permlane16_swap_b32 v50, v51
    v_max_f32 v48, v48, v49
    v_max_f32 v50, v50, v51
    v_mov_b32 v49, v48
    v_mov_b32 v51, v50
    s_nop 0
    v_permlane32_swap_b32 v48, v49
    v_permlane32_swap_b32 v50, v51
    v_max_f32 v48, v48, v49
    v_max_f32 v50, v50, v51
    v_sub_f32 v49, v44, v48
    v_sub_f32 v51, v46, v50
    v_mul_f32 v49, s76, v49
    v_mul_f32 v51, s76, v51
    v_exp_f32 v49, v49
    v_exp_f32 v51, v51
    v_mul_f32 v44, 0x3e000000, v48
    v_mul_f32 v46, 0x3e000000, v50
    v_mul_f32 v45, v45, v49
    v_mul_f32 v47, v47, v51
    v_readlane_b32 s9, v49, s8
    v_readlane_b32 s8, v51, s8
    v_permlane32_swap_b32 v44, v46
    v_permlane32_swap_b32 v45, v47
    v_add_f32 v44, v44, v46
    v_add_f32 v45, v45, v47
    s_nop 1
    v_permlane16_swap_b32 v44, v45
    v_add_f32 v44, v44, v45
    v_mov_b32 v48, s9
    v_mov_b32 v49, s8
    v_add_f32_dpp v44, v44, v44 row_ror:8 row_mask:0xf bank_mask:0xf
    v_cndmask_b32 v48, v48, v49, s[90:91]
    v_bfi_b32 v44, s72, v202, v44
    s_mov_b64 exec, s[10:11]
    s_cmp_eq_u32 s74, 0
    s_cbranch_scc1 L_ls13
    buffer_store_dword v44, v19, s[44:47], s12 offen
    s_branch L_le14
L_ls13:
    buffer_store_dword v44, v19, s[44:47], s12 offen sc1
L_le14:
    s_mov_b64 exec, -1
    s_waitcnt vmcnt(7)
    v_mfma_f32_16x16x32_bf16 v[40:43], v[76:79], v[108:111], v[40:43]
    s_waitcnt vmcnt(6)
    v_mfma_f32_16x16x32_bf16 v[40:43], v[80:83], v[112:115], v[40:43]
    s_waitcnt vmcnt(5)
    v_mfma_f32_16x16x32_bf16 v[40:43], v[84:87], v[116:119], v[40:43]
    s_waitcnt vmcnt(4)
    v_mfma_f32_16x16x32_bf16 v[40:43], v[88:91], v[120:123], v[40:43]
    s_waitcnt vmcnt(3)
    v_mfma_f32_16x16x32_bf16 v[40:43], v[92:95], v[124:127], v[40:43]
    s_nop 7
    v_mul_f32 v40, v40, v48
    v_mul_f32 v41, v41, v48
    v_mul_f32 v42, v42, v48
    v_mul_f32 v43, v43, v48
    ds_write2_b32 v22, v40, v41 offset0:0 offset1:4
    ds_write2_b32 v22, v42, v43 offset0:8 offset1:12
    s_waitcnt lgkmcnt(0)
    s_barrier
    ds_read_b128 v[40:43], v23 offset:5120
    s_waitcnt lgkmcnt(0)
    v_permlane32_swap_b32 v40, v42
    v_permlane32_swap_b32 v41, v43
    v_add_f32 v40, v40, v42
    v_add_f32 v41, v41, v43
    s_nop 1
    v_permlane16_swap_b32 v40, v41
    v_add_f32 v40, v40, v41
    s_nop 1
    v_add_f32_dpp v40, v40, v40 row_ror:8 row_mask:0xf bank_mask:0xf
    v_bfi_b32 v40, s72, v216, v40
    s_mov_b64 exec, s[84:85]
    s_cmp_eq_u32 s74, 0
    s_cbranch_scc1 L_ls15
    buffer_store_dword v40, v20, s[44:47], s13 offen
    s_branch L_le16
L_ls15:
    buffer_store_dword v40, v20, s[44:47], s13 offen sc1
L_le16:
    s_mov_b64 exec, -1
    s_barrier
    buffer_load_dwordx4 v[172:175], v12, s[60:63], s14 offen nt
    s_add_u32 s14, s14, 9216
    buffer_load_dwordx4 v[176:179], v12, s[60:63], s14 offen nt
    s_add_u32 s14, s14, 9216
    buffer_load_dwordx4 v[180:183], v12, s[60:63], s14 offen nt
    s_add_u32 s14, s14, 9216
    buffer_load_dwordx4 v[184:187], v12, s[60:63], s14 offen nt
    s_add_u32 s14, s14, 9216
    buffer_load_dwordx4 v[188:191], v12, s[60:63], s14 offen nt
    s_add_u32 s14, s14, 9216
    buffer_load_dwordx4 v[192:195], v12, s[60:63], s14 offen nt
    s_add_u32 s14, s14, 9216
    buffer_load_dwordx4 v[196:199], v13, s[60:63], s14 offen nt
    s_add_u32 s14, s14, 9216
    s_mul_i32 s8, s3, 2304
    s_mul_i32 s9, s5, 288
    s_add_u32 s8, s8, s9
    s_add_u32 s8, s8, 950272
    s_mul_i32 s10, s3, 6912
    s_add_u32 s10, s10, 1703936
    s_add_u32 s11, s10, 4608
    s_add_u32 s10, s10, s9
    v_lshrrev_b32 v16, 3, v0
    v_lshlrev_b32 v27, 2, v16
    v_and_b32 v16, 15, v0
    v_min_u32 v17, 8, v16
    v_lshlrev_b32 v26, 4, v17
    v_cmp_gt_u32 vcc, 9, v16
    v_mov_b32 v16, 0x3ae38e39
    s_nop 0
    v_cndmask_b32 v28, 0, v16, vcc
    s_mul_i32 s12, s3, 18
    s_add_u32 s12, s12, s6
    s_lshl_b32 s12, s12, 9
    s_add_u32 s12, s12, 1572864
    s_sub_u32 s13, s15, s6
    s_lshl_b32 s13, s13, 9
    s_add_u32 s13, s13, s12
    s_add_u32 s13, s13, 4
    s_cmp_eq_u32 s5, 1
    s_cselect_b32 s12, s13, s12
    s_cselect_b32 s13, 1088, 0
    v_add_u32 v25, s13, v208
    v_lshlrev_b32 v24, 3, v0
    s_mov_b32 s70, 0x05040100
    s_mov_b32 s82, 0xffff0000
    s_mov_b32 s83, 0xffff0000
    s_waitcnt vmcnt(7)
    v_perm_b32 v64, v168, v164, s70
    v_perm_b32 v68, v168, v164, s75
    v_perm_b32 v72, v169, v165, s70
    v_perm_b32 v76, v169, v165, s75
    v_perm_b32 v80, v170, v166, s70
    v_perm_b32 v84, v170, v166, s75
    v_perm_b32 v88, v171, v167, s70
    v_perm_b32 v92, v171, v167, s75
    s_waitcnt vmcnt(5)
    v_perm_b32 v65, v176, v172, s70
    v_perm_b32 v69, v176, v172, s75
    v_perm_b32 v73, v177, v173, s70
    v_perm_b32 v77, v177, v173, s75
    v_perm_b32 v81, v178, v174, s70
    v_perm_b32 v85, v178, v174, s75
    v_perm_b32 v89, v179, v175, s70
    v_perm_b32 v93, v179, v175, s75
    s_waitcnt vmcnt(3)
    v_perm_b32 v66, v184, v180, s70
    v_perm_b32 v70, v184, v180, s75
    v_perm_b32 v74, v185, v181, s70
    v_perm_b32 v78, v185, v181, s75
    v_perm_b32 v82, v186, v182, s70
    v_perm_b32 v86, v186, v182, s75
    v_perm_b32 v90, v187, v183, s70
    v_perm_b32 v94, v187, v183, s75
    s_waitcnt vmcnt(1)
    v_perm_b32 v67, v192, v188, s70
    v_perm_b32 v71, v192, v188, s75
    v_perm_b32 v75, v193, v189, s70
    v_perm_b32 v79, v193, v189, s75
    v_perm_b32 v83, v194, v190, s70
    v_perm_b32 v87, v194, v190, s75
    v_perm_b32 v91, v195, v191, s70
    v_perm_b32 v95, v195, v191, s75
    s_mov_b32 s7, 0
L_poll17:
    buffer_load_dword v58, v234, s[44:47], s10 offen sc1
    buffer_load_dword v59, v27, s[44:47], s10 offen offset:256 sc1
    buffer_load_dword v60, v234, s[44:47], s10 offen offset:2304 sc1
    buffer_load_dword v61, v27, s[44:47], s10 offen offset:2560 sc1
    s_add_u32 s7, s7, 1
    s_cmp_gt_u32 s7, 400000
    s_cbranch_scc1 L_end
    s_waitcnt vmcnt(0)
    v_xor_b32 v58, v58, v216
    v_xor_b32 v59, v59, v217
    v_xor_b32 v60, v60, v216
    v_xor_b32 v61, v61, v217
    v_or3_b32 v236, v58, v59, v60
    v_bitop3_b32 v21, v61, v236, s72 bitop3:0xa8
    v_cmp_ne_u32 vcc, 0, v21
    s_cbranch_vccnz L_poll17
    s_mov_b32 s7, 0
L_poll18:
    buffer_load_dwordx4 v[44:47], v26, s[44:47], s11 offen sc1
    buffer_load_dword v62, v234, s[44:47], s8 offen sc1
    buffer_load_dword v63, v27, s[44:47], s8 offen offset:256 sc1
    s_add_u32 s7, s7, 1
    s_cmp_gt_u32 s7, 400000
    s_cbranch_scc1 L_end
    s_waitcnt vmcnt(0)
    v_xor_b32 v44, v44, v6
    v_xor_b32 v45, v45, v7
    v_xor_b32 v46, v46, v8
    v_xor_b32 v47, v47, v9
    v_xor_b32 v62, v62, v216
    v_xor_b32 v63, v63, v217
    v_or3_b32 v236, v44, v45, v46
    v_or3_b32 v237, v47, v62, v63
    v_bitop3_b32 v21, v236, v237, s72 bitop3:0xa8
    v_cmp_ne_u32 vcc, 0, v21
    s_cbranch_vccnz L_poll18
    v_add_f32 v44, v44, v45
    v_add_f32 v46, v46, v47
    v_mul_f32 v44, v44, v28
    v_mul_f32 v46, v46, v28
    s_nop 0
    v_add_f32_dpp v44, v44, v44 row_ror:8 row_mask:0xf bank_mask:0xf
    v_add_f32_dpp v46, v46, v46 row_ror:8 row_mask:0xf bank_mask:0xf
    s_nop 0
    v_add_f32_dpp v44, v44, v44 row_ror:4 row_mask:0xf bank_mask:0xf
    v_add_f32_dpp v46, v46, v46 row_ror:4 row_mask:0xf bank_mask:0xf
    s_nop 0
    v_add_f32_dpp v44, v44, v44 row_ror:2 row_mask:0xf bank_mask:0xf
    v_add_f32_dpp v46, v46, v46 row_ror:2 row_mask:0xf bank_mask:0xf
    s_nop 0
    v_add_f32_dpp v44, v44, v44 row_ror:1 row_mask:0xf bank_mask:0xf
    v_add_f32_dpp v46, v46, v46 row_ror:1 row_mask:0xf bank_mask:0xf
    v_fma_f32 v46, -v44, v44, v46
    v_fma_f32 v62, -v44, v58, v62
    v_max_f32 v46, 0, v46
    v_fma_f32 v63, -v44, v59, v63
    v_add_f32 v46, 0x3727c5ac, v46
    v_rsq_f32 v46, v46
    s_nop 0
    v_fma_f32 v62, v62, v46, v60
    v_fma_f32 v63, v63, v46, v61
    s_nop 0
    v_mov_b32_dpp v46, v62 quad_perm:[1,0,3,2] row_mask:0xf bank_mask:0xf
    v_cvt_pk_bf16_f32 v56, v63, v63
    v_cvt_pk_bf16_f32 v47, v62, v46
    ds_swizzle_b32 v48, v47 offset:24
    ds_swizzle_b32 v49, v47 offset:88
    ds_swizzle_b32 v50, v47 offset:152
    ds_swizzle_b32 v51, v47 offset:216
    v_and_b32 v52, v56, v2
    v_and_b32 v53, v56, v3
    v_and_b32 v54, v56, v4
    v_and_b32 v55, v56, v5
    s_nop 1
    v_mfma_f32_16x16x32_bf16 v[40:43], v[52:55], v[196:199], 0
    s_waitcnt lgkmcnt(0)
    v_mfma_f32_16x16x32_bf16 v[96:99], v[48:51], v[64:67], v[40:43]
    v_mfma_f32_16x16x32_bf16 v[112:115], v[48:51], v[80:83], v[40:43]
    v_mfma_f32_16x16x32_bf16 v[104:107], v[48:51], v[72:75], v[40:43]
    v_mfma_f32_16x16x32_bf16 v[120:123], v[48:51], v[88:91], v[40:43]
    v_mfma_f32_16x16x32_bf16 v[100:103], v[48:51], v[68:71], v[40:43]
    v_mfma_f32_16x16x32_bf16 v[116:119], v[48:51], v[84:87], v[40:43]
    v_mfma_f32_16x16x32_bf16 v[108:111], v[48:51], v[76:79], v[40:43]
    v_mfma_f32_16x16x32_bf16 v[124:127], v[48:51], v[92:95], v[40:43]
    s_nop 2
    v_cndmask_b32 v40, v96, v112, s[82:83]
    v_cndmask_b32 v42, v106, v122, s[82:83]
    s_nop 0
    v_cndmask_b32 v41, v101, v117, s[82:83]
    s_nop 0
    v_cndmask_b32 v43, v111, v127, s[82:83]
    v_permlane32_swap_b32 v40, v42
    s_nop 0
    v_permlane32_swap_b32 v41, v43
    v_add_f32_dpp v40, v42, v40 row_ror:8 row_mask:0xf bank_mask:0xf
    s_nop 0
    v_add_f32_dpp v41, v43, v41 row_ror:8 row_mask:0xf bank_mask:0xf
    s_mov_b64 exec, s[84:85]
    ds_write_b32 v204, v40 offset:0
    ds_write_b32 v211, v41 offset:0
    s_mov_b64 exec, -1
    s_waitcnt lgkmcnt(0)
    s_barrier
    s_mul_i32 s12, s3, 36
    s_add_u32 s12, s12, s6
    s_lshl_b32 s12, s12, 8
    s_add_u32 s12, s12, 1572864
    s_cmp_lg_u32 s5, 0
    s_cbranch_scc1 L_ap19
    ds_read_b128 v[16:19], v208 offset:0
    ds_read_b128 v[20:23], v208 offset:1088
    s_waitcnt lgkmcnt(0)
    v_pk_add_f32 v[16:17], v[16:17], v[20:21]
    v_pk_add_f32 v[18:19], v[18:19], v[22:23]
    s_nop 1
    v_permlane32_swap_b32 v16, v18
    v_permlane32_swap_b32 v17, v19
    v_pk_add_f32 v[16:17], v[16:17], v[18:19]
    s_nop 1
    v_permlane16_swap_b32 v16, v17
    v_add_f32 v16, v16, v17
    v_cvt_pk_bf16_f32 v16, v16, v16
    v_bfi_b32 v16, s72, v216, v16
    s_cmp_eq_u32 s74, 0
    s_cbranch_scc1 L_ls20
    buffer_store_dword v16, v234, s[44:47], s12 offen
    s_branch L_le21
L_ls20:
    buffer_store_dword v16, v234, s[44:47], s12 offen sc1
L_le21:
L_ap19:
    s_branch L_fin
L_WD:
    s_sub_u32 s6, s4, 18
    s_mov_b32 s56, s24
    s_mov_b32 s57, s25
    s_mov_b32 s58, 4718592
    s_mov_b32 s59, 0x20000
    s_mov_b32 s60, s32
    s_mov_b32 s61, s33
    s_mov_b32 s62, 5308416
    s_mov_b32 s63, 0x20000
    v_and_b32 v16, 8, v0
    v_lshlrev_b32 v16, 2, v16
    v_lshrrev_b32 v17, 4, v0
    v_add_u32 v16, v16, v17
    v_mul_u32_u24 v16, 1152, v16
    v_and_b32 v17, 0x70, v1
    v_add_u32 v12, v16, v17
    s_lshl_b32 s14, s3, 3
    s_add_u32 s14, s14, s5
    s_mul_i32 s15, s14, 82944
    s_mul_i32 s14, s14, 73728
    s_lshl_b32 s8, s6, 7
    s_add_u32 s14, s14, s8
    s_add_u32 s15, s15, s8
    s_cmp_lg_u32 s5, 3
    s_cbranch_scc1 L_tch22
    v_lshlrev_b32 v17, 7, v0
    s_lshl_b32 s8, s3, 5
    s_add_u32 s8, s8, s4
    s_mul_i32 s8, s8, 1152
    s_add_u32 s8, s8, 458752
    s_mov_b32 exec_lo, 255
    s_mov_b32 exec_hi, 0
    buffer_load_dword v205, v17, s[44:47], s8 offen sc1
    s_mov_b64 exec, -1
L_tch22:
    buffer_load_dwordx4 v[128:131], v12, s[56:59], s14 offen nt
    s_add_u32 s14, s14, 4608
    buffer_load_dwordx4 v[132:135], v12, s[56:59], s14 offen nt
    s_add_u32 s14, s14, 4608
    s_mul_i32 s9, s3, 36864
    s_lshr_b32 s10, s4, 4
    s_lshl_b32 s10, s10, 10
    s_add_u32 s9, s9, s10
    s_lshl_b32 s10, s5, 7
    s_add_u32 s9, s9, s10
    s_add_u32 s9, s9, 65536
    s_add_u32 s11, s9, 16384
    s_add_u32 s64, s9, 32768
    v_lshrrev_b32 v16, 3, v0
    v_lshlrev_b32 v16, 11, v16
    v_and_b32 v17, 0x70, v1
    v_add_u32 v28, v16, v17
    v_and_b32 v16, 3, v0
    v_lshlrev_b32 v16, 4, v16
    v_and_b32 v17, 4, v0
    v_lshrrev_b32 v18, 5, v0
    v_lshlrev_b32 v18, 3, v18
    v_add3_u32 v16, v16, v17, v18
    v_bfe_u32 v17, v0, 4, 1
    s_lshr_b32 s10, s5, 1
    s_lshl_b32 s10, s10, 6
    s_and_b32 s8, s5, 1
    s_lshl_b32 s8, s8, 1
    s_add_u32 s10, s10, s8
    v_add3_u32 v16, v16, v17, s10
    v_lshlrev_b32 v26, 1, v16
    v_and_b32 v16, 8, v0
    v_lshlrev_b32 v29, 2, v16
    v_lshlrev_b32 v16, 5, v16
    v_and_b32 v18, 3, v0
    v_lshlrev_b32 v18, 6, v18
    v_and_b32 v17, 0x30, v0
    v_add3_u32 v27, v16, v17, v18
    s_lshl_b32 s8, s5, 2
    v_add_u32 v30, s8, v29
    v_and_b32 v16, 32, v0
    v_lshlrev_b32 v16, 2, v16
    v_and_b32 v17, 12, v0
    v_lshlrev_b32 v17, 3, v17
    v_and_b32 v18, 19, v0
    v_add3_u32 v22, v16, v17, v18
    s_mul_i32 s8, s5, 1152
    s_add_u32 s10, s8, 5120
    v_lshl_add_u32 v22, v22, 2, s10
    v_and_b32 v16, 8, v0
    v_add_u32 v31, s8, v16
    v_lshrrev_b32 v16, 3, v0
    v_mul_u32_u24 v24, 1152, v16
    v_and_b32 v17, 0x70, v1
    s_lshl_b32 s8, s5, 7
    v_add3_u32 v23, v24, v17, s8
    v_and_b32 v16, 0x30, v0
    v_lshrrev_b32 v19, 2, v16
    v_lshrrev_b32 v17, 2, v17
    v_lshl_add_u32 v20, v16, 1, v17
    s_lshl_b32 s12, s3, 5
    s_add_u32 s12, s12, s4
    s_mul_i32 s12, s12, 1152
    s_add_u32 s12, s12, 458752
    s_add_u32 s13, s12, s8
    s_waitcnt vmcnt(3)
    buffer_load_dwordx4 v[136:139], v12, s[56:59], s14 offen nt
    s_add_u32 s14, s14, 4608
    s_waitcnt vmcnt(3)
    buffer_load_dwordx4 v[140:143], v12, s[56:59], s14 offen nt
    s_add_u32 s14, s14, 4608
    s_waitcnt vmcnt(3)
    buffer_load_dwordx4 v[144:147], v12, s[56:59], s14 offen nt
    s_add_u32 s14, s14, 4608
    s_waitcnt vmcnt(3)
    buffer_load_dwordx4 v[148:151], v12, s[56:59], s14 offen nt
    s_add_u32 s14, s14, 4608
    s_waitcnt vmcnt(3)
    s_add_u32 s77, s94, 737280
    s_and_b32 s77, s77, 0xfffff
    buffer_load_dwordx4 v[72:75], v14, s[48:51], s77 offen nt
    s_waitcnt vmcnt(3)
    s_add_u32 s77, s94, 1105920
    s_and_b32 s77, s77, 0xfffff
    buffer_load_dwordx4 v[76:79], v14, s[48:51], s77 offen nt
    s_waitcnt vmcnt(3)
    s_add_u32 s77, s94, 1474560
    s_and_b32 s77, s77, 0xfffff
    buffer_load_dwordx4 v[80:83], v14, s[48:51], s77 offen nt
    s_waitcnt vmcnt(3)
    s_add_u32 s77, s94, 1843200
    s_and_b32 s77, s77, 0xfffff
    buffer_load_dwordx4 v[84:87], v14, s[48:51], s77 offen nt
    s_waitcnt vmcnt(3)
    s_add_u32 s77, s94, 2211840
    s_and_b32 s77, s77, 0xfffff
    buffer_load_dwordx4 v[88:91], v14, s[48:51], s77 offen nt
    s_waitcnt vmcnt(3)
    s_add_u32 s77, s94, 2580480
    s_and_b32 s77, s77, 0xfffff
    buffer_load_dwordx4 v[92:95], v14, s[48:51], s77 offen nt
    s_waitcnt vmcnt(3)
    s_add_u32 s77, s94, 0
    s_and_b32 s77, s77, 0xfffff
    buffer_load_dwordx4 v[96:99], v210, s[52:55], s77 offen nt
    s_waitcnt vmcnt(3)
    s_add_u32 s77, s94, 368640
    s_and_b32 s77, s77, 0xfffff
    buffer_load_dwordx4 v[100:103], v210, s[52:55], s77 offen nt
    s_waitcnt vmcnt(3)
    s_add_u32 s77, s94, 737280
    s_and_b32 s77, s77, 0xfffff
    buffer_load_dwordx4 v[104:107], v210, s[52:55], s77 offen nt
    s_lshl_b32 s10, s3, 9
    s_add_u32 s10, s10, 1015808
    v_and_b32 v16, 0x1f0, v1
    buffer_load_dwordx4 v[40:43], v16, s[44:47], s10 offen sc1
    v_mov_b32 v44, v6
    v_mov_b32 v45, v7
    v_mov_b32 v46, v8
    v_mov_b32 v47, v9
    buffer_load_dwordx4 v[32:35], v28, s[44:47], s9 offen sc1
    buffer_load_dwordx4 v[36:39], v28, s[44:47], s11 offen sc1
    s_mov_b64 exec, 0xffff
    buffer_load_dwordx4 v[44:47], v28, s[44:47], s64 offen sc1
    s_mov_b64 exec, -1
    s_waitcnt vmcnt(7)
    s_add_u32 s77, s94, 1105920
    s_and_b32 s77, s77, 0xfffff
    buffer_load_dwordx4 v[108:111], v210, s[52:55], s77 offen nt
    s_waitcnt vmcnt(7)
    s_add_u32 s77, s94, 1474560
    s_and_b32 s77, s77, 0xfffff
    buffer_load_dwordx4 v[112:115], v210, s[52:55], s77 offen nt
    s_waitcnt vmcnt(7)
    s_add_u32 s77, s94, 1843200
    s_and_b32 s77, s77, 0xfffff
    buffer_load_dwordx4 v[116:119], v210, s[52:55], s77 offen nt
    s_waitcnt vmcnt(3)
    v_readfirstlane_b32 s10, v40
    v_xor_b32 v17, v40, v6
    v_bitop3_b32 v17, v41, v7, v17 bitop3:0xbe
    v_bitop3_b32 v17, v42, v8, v17 bitop3:0xbe
    v_bitop3_b32 v17, v43, v9, v17 bitop3:0xbe
    v_and_b32 v17, s72, v17
    v_xor_b32 v18, s10, v40
    v_or_b32 v17, v17, v18
    v_cmp_ne_u32 vcc, 0, v17
    s_cmp_eq_u64 vcc, 0
    s_cselect_b32 s74, 1, 0
    v_xor_b32 v32, v32, v6
    v_xor_b32 v33, v33, v7
    v_xor_b32 v34, v34, v8
    v_xor_b32 v35, v35, v9
    v_xor_b32 v36, v36, v6
    v_xor_b32 v37, v37, v7
    v_xor_b32 v38, v38, v8
    v_xor_b32 v39, v39, v9
    v_xor_b32 v44, v44, v6
    v_xor_b32 v45, v45, v7
    v_xor_b32 v46, v46, v8
    v_xor_b32 v47, v47, v9
    v_or3_b32 v236, v32, v33, v34
    v_or3_b32 v237, v35, v36, v37
    v_or3_b32 v238, v38, v39, v44
    v_or3_b32 v239, v45, v46, v47
    v_or3_b32 v240, v236, v237, v238
    v_bitop3_b32 v21, v239, v240, s72 bitop3:0xa8
    v_cmp_ne_u32 vcc, 0, v21
    s_cbranch_vccz L_qok23
    s_mov_b32 s7, 0
L_poll24:
    v_mov_b32 v44, v6
    v_mov_b32 v45, v7
    v_mov_b32 v46, v8
    v_mov_b32 v47, v9
    buffer_load_dwordx4 v[32:35], v28, s[44:47], s9 offen sc1
    buffer_load_dwordx4 v[36:39], v28, s[44:47], s11 offen sc1
    s_mov_b64 exec, 0xffff
    buffer_load_dwordx4 v[44:47], v28, s[44:47], s64 offen sc1
    s_mov_b64 exec, -1
    s_add_u32 s7, s7, 1
    s_cmp_gt_u32 s7, 400000
    s_cbranch_scc1 L_end
    s_waitcnt vmcnt(0)
    v_xor_b32 v32, v32, v6
    v_xor_b32 v33, v33, v7
    v_xor_b32 v34, v34, v8
    v_xor_b32 v35, v35, v9
    v_xor_b32 v36, v36, v6
    v_xor_b32 v37, v37, v7
    v_xor_b32 v38, v38, v8
    v_xor_b32 v39, v39, v9
    v_xor_b32 v44, v44, v6
    v_xor_b32 v45, v45, v7
    v_xor_b32 v46, v46, v8
    v_xor_b32 v47, v47, v9
    v_or3_b32 v236, v32, v33, v34
    v_or3_b32 v237, v35, v36, v37
    v_or3_b32 v238, v38, v39, v44
    v_or3_b32 v239, v45, v46, v47
    v_or3_b32 v240, v236, v237, v238
    v_bitop3_b32 v21, v239, v240, s72 bitop3:0xa8
    v_cmp_ne_u32 vcc, 0, v21
    s_cbranch_vccnz L_poll24
L_qok23:
    s_waitcnt vmcnt(7)
    s_add_u32 s77, s94, 2211840
    s_and_b32 s77, s77, 0xfffff
    buffer_load_dwordx4 v[120:123], v210, s[52:55], s77 offen nt
    v_pk_add_f32 v[32:33], v[32:33], v[44:45]
    v_pk_add_f32 v[34:35], v[34:35], v[46:47]
    v_pk_add_f32 v[32:33], v[32:33], v[36:37]
    v_pk_add_f32 v[34:35], v[34:35], v[38:39]
    s_nop 1
    v_permlane32_swap_b32 v32, v34
    v_permlane32_swap_b32 v33, v35
    v_pk_add_f32 v[32:33], v[32:33], v[34:35]
    s_nop 1
    v_permlane16_swap_b32 v32, v33
    v_add_f32 v32, v32, v33
    s_nop 1
    v_add_f32_dpp v32, v32, v32 row_ror:8 row_mask:0xf bank_mask:0xf
    v_cvt_pk_bf16_f32 v32, v32, v32
    ds_write_b16 v26, v32 offset:14336
    s_waitcnt lgkmcnt(0)
    s_barrier
    ds_read_b128 v[32:35], v27 offset:14336
    s_add_u32 s77, s94, 2580480
    s_and_b32 s77, s77, 0xfffff
    buffer_load_dwordx4 v[124:127], v210, s[52:55], s77 offen nt
    s_waitcnt lgkmcnt(0)
    v_cndmask_b32 v36, v32, 0, s[86:87]
    v_cndmask_b32 v37, v33, 0, s[86:87]
    v_cndmask_b32 v38, v34, 0, s[86:87]
    v_cndmask_b32 v39, v35, 0, s[86:87]
    v_cndmask_b32 v32, 0, v32, s[86:87]
    v_cndmask_b32 v33, 0, v33, s[86:87]
    v_cndmask_b32 v34, 0, v34, s[86:87]
    v_cndmask_b32 v35, 0, v35, s[86:87]
    v_mfma_f32_16x16x32_bf16 v[40:43], v[68:71], v[36:39], 0
    v_mfma_f32_16x16x32_bf16 v[44:47], v[76:79], v[36:39], 0
    v_mfma_f32_16x16x32_bf16 v[48:51], v[84:87], v[36:39], 0
    v_mfma_f32_16x16x32_bf16 v[52:55], v[92:95], v[36:39], 0
    v_mfma_f32_16x16x32_bf16 v[40:43], v[64:67], v[32:35], v[40:43]
    v_mfma_f32_16x16x32_bf16 v[44:47], v[72:75], v[32:35], v[44:47]
    v_mfma_f32_16x16x32_bf16 v[48:51], v[80:83], v[32:35], v[48:51]
    v_mfma_f32_16x16x32_bf16 v[52:55], v[88:91], v[32:35], v[52:55]
    s_lshl_b32 s12, s3, 5
    s_add_u32 s12, s12, s4
    s_lshl_b32 s12, s12, 4
    s_add_u32 s12, s12, 1024000
    s_lshl_b32 s8, s5, 3
    s_mov_b32 s10, 0x00010001
    s_mov_b32 s11, 0x00010001
    v_mov_b32_dpp v56, v40 quad_perm:[0,0,0,0] row_mask:0xf bank_mask:0xf
    v_add_f32_dpp v56, v41, v56 quad_perm:[1,1,1,1] row_mask:0xf bank_mask:0xf
    v_add_f32_dpp v56, v42, v56 quad_perm:[2,2,2,2] row_mask:0xf bank_mask:0xf
    v_add_f32_dpp v56, v43, v56 quad_perm:[3,3,3,3] row_mask:0xf bank_mask:0xf
    v_mov_b32_dpp v57, v44 quad_perm:[0,0,0,0] row_mask:0xf bank_mask:0xf
    v_add_f32_dpp v57, v45, v57 quad_perm:[1,1,1,1] row_mask:0xf bank_mask:0xf
    v_add_f32_dpp v57, v46, v57 quad_perm:[2,2,2,2] row_mask:0xf bank_mask:0xf
    v_add_f32_dpp v57, v47, v57 quad_perm:[3,3,3,3] row_mask:0xf bank_mask:0xf
    v_mov_b32_dpp v58, v48 quad_perm:[0,0,0,0] row_mask:0xf bank_mask:0xf
    v_add_f32_dpp v58, v49, v58 quad_perm:[1,1,1,1] row_mask:0xf bank_mask:0xf
    v_add_f32_dpp v58, v50, v58 quad_perm:[2,2,2,2] row_mask:0xf bank_mask:0xf
    v_add_f32_dpp v58, v51, v58 quad_perm:[3,3,3,3] row_mask:0xf bank_mask:0xf
    v_mov_b32_dpp v59, v52 quad_perm:[0,0,0,0] row_mask:0xf bank_mask:0xf
    v_add_f32_dpp v59, v53, v59 quad_perm:[1,1,1,1] row_mask:0xf bank_mask:0xf
    v_add_f32_dpp v59, v54, v59 quad_perm:[2,2,2,2] row_mask:0xf bank_mask:0xf
    v_add_f32_dpp v59, v55, v59 quad_perm:[3,3,3,3] row_mask:0xf bank_mask:0xf
    v_cvt_pk_bf16_f32 v60, v56, v57
    v_lshlrev_b32 v56, 16, v60
    v_and_b32 v57, s73, v60
    v_cvt_pk_bf16_f32 v61, v58, v59
    v_lshlrev_b32 v58, 16, v61
    v_and_b32 v59, s73, v61
    v_mul_f32 v56, 0x3db504f3, v56
    v_mul_f32 v57, 0x3db504f3, v57
    v_mul_f32 v58, 0x3db504f3, v58
    v_mul_f32 v59, 0x3db504f3, v59
    v_cvt_pk_bf16_f32 v60, v56, v57
    v_lshlrev_b32 v56, 16, v60
    v_and_b32 v57, s73, v60
    v_cvt_pk_bf16_f32 v61, v58, v59
    v_lshlrev_b32 v58, 16, v61
    v_and_b32 v59, s73, v61
    v_max3_f32 v60, v56, v57, v58
    v_max_f32 v60, v60, v59
    s_nop 1
    v_max_f32_dpp v60, v60, v60 row_half_mirror row_mask:0xf bank_mask:0xf
    v_mov_b32 v61, v60
    s_nop 1
    v_permlane16_swap_b32 v60, v61
    v_max_f32 v60, v60, v61
    v_mov_b32 v61, v60
    s_nop 1
    v_permlane32_swap_b32 v60, v61
    v_max_f32 v60, v60, v61
    buffer_load_dwordx4 v[152:155], v12, s[56:59], s14 offen nt
    s_add_u32 s14, s14, 4608
    buffer_load_dwordx4 v[156:159], v12, s[56:59], s14 offen nt
    s_add_u32 s14, s14, 4608
    v_sub_f32 v56, v56, v60
    v_sub_f32 v57, v57, v60
    v_sub_f32 v58, v58, v60
    v_sub_f32 v59, v59, v60
    v_mul_f32 v56, s76, v56
    v_mul_f32 v57, s76, v57
    v_mul_f32 v58, s76, v58
    v_mul_f32 v59, s76, v59
    v_exp_f32 v56, v56
    v_exp_f32 v57, v57
    v_exp_f32 v58, v58
    v_exp_f32 v59, v59
    v_cvt_pk_bf16_f32 v56, v56, v56
    v_cvt_pk_bf16_f32 v57, v57, v57
    v_cvt_pk_bf16_f32 v58, v58, v58
    v_cvt_pk_bf16_f32 v59, v59, v59
    v_and_b32 v44, s73, v56
    v_and_b32 v45, s73, v57
    v_and_b32 v46, s73, v58
    v_and_b32 v47, s73, v59
    v_add_f32 v44, v44, v45
    v_add_f32 v46, v46, v47
    v_add_f32 v61, v44, v46
    v_and_b32 v64, v56, v2
    v_and_b32 v65, v56, v3
    v_and_b32_dpp v66, v56, v4 row_shr:4 row_mask:0xf bank_mask:0xf bound_ctrl:0
    v_and_b32_dpp v67, v56, v5 row_shr:4 row_mask:0xf bank_mask:0xf bound_ctrl:0
    v_add_f32_dpp v61, v61, v61 row_half_mirror row_mask:0xf bank_mask:0xf
    v_mov_b32 v44, v61
    v_and_b32_dpp v68, v56, v2 row_shl:4 row_mask:0xf bank_mask:0xf bound_ctrl:0
    v_and_b32_dpp v69, v56, v3 row_shl:4 row_mask:0xf bank_mask:0xf bound_ctrl:0
    v_and_b32 v70, v56, v4
    v_and_b32 v71, v56, v5
    v_permlane16_swap_b32 v61, v44
    v_add_f32 v61, v61, v44
    v_mov_b32 v44, v61
    v_and_b32 v72, v57, v2
    v_and_b32 v73, v57, v3
    v_and_b32_dpp v74, v57, v4 row_shr:4 row_mask:0xf bank_mask:0xf bound_ctrl:0
    v_and_b32_dpp v75, v57, v5 row_shr:4 row_mask:0xf bank_mask:0xf bound_ctrl:0
    v_permlane32_swap_b32 v61, v44
    v_add_f32 v61, v61, v44
    s_mov_b64 exec, 0x101
    ds_write_b64 v31, v[60:61] offset:6144
    s_mov_b64 exec, -1
    v_and_b32_dpp v76, v57, v2 row_shl:4 row_mask:0xf bank_mask:0xf bound_ctrl:0
    v_and_b32_dpp v77, v57, v3 row_shl:4 row_mask:0xf bank_mask:0xf bound_ctrl:0
    v_and_b32 v78, v57, v4
    v_and_b32 v79, v57, v5
    v_and_b32 v80, v58, v2
    v_and_b32 v81, v58, v3
    v_and_b32_dpp v82, v58, v4 row_shr:4 row_mask:0xf bank_mask:0xf bound_ctrl:0
    v_and_b32_dpp v83, v58, v5 row_shr:4 row_mask:0xf bank_mask:0xf bound_ctrl:0
    v_and_b32_dpp v84, v58, v2 row_shl:4 row_mask:0xf bank_mask:0xf bound_ctrl:0
    v_and_b32_dpp v85, v58, v3 row_shl:4 row_mask:0xf bank_mask:0xf bound_ctrl:0
    v_and_b32 v86, v58, v4
    v_and_b32 v87, v58, v5
    v_and_b32 v88, v59, v2
    v_and_b32 v89, v59, v3
    v_and_b32_dpp v90, v59, v4 row_shr:4 row_mask:0xf bank_mask:0xf bound_ctrl:0
    v_and_b32_dpp v91, v59, v5 row_shr:4 row_mask:0xf bank_mask:0xf bound_ctrl:0
    v_and_b32_dpp v92, v59, v2 row_shl:4 row_mask:0xf bank_mask:0xf bound_ctrl:0
    v_and_b32_dpp v93, v59, v3 row_shl:4 row_mask:0xf bank_mask:0xf bound_ctrl:0
    v_and_b32 v94, v59, v4
    v_and_b32 v95, v59, v5
    s_waitcnt lgkmcnt(0)
    s_barrier
    ds_read_b128 v[44:47], v24 offset:6144
    s_waitcnt vmcnt(13)
    v_mfma_f32_16x16x32_bf16 v[40:43], v[64:67], v[96:99], 0
    s_waitcnt vmcnt(12)
    v_mfma_f32_16x16x32_bf16 v[40:43], v[68:71], v[100:103], v[40:43]
    s_waitcnt vmcnt(11)
    v_mfma_f32_16x16x32_bf16 v[40:43], v[72:75], v[104:107], v[40:43]
    s_waitcnt lgkmcnt(0)
    v_max_f32_dpp v48, v44, v44 row_ror:8 row_mask:0xf bank_mask:0xf
    v_max_f32_dpp v50, v46, v46 row_ror:8 row_mask:0xf bank_mask:0xf
    v_mov_b32 v49, v48
    v_mov_b32 v51, v50
    s_nop 0
    v_permlane16_swap_b32 v48, v49
    v_permlane16_swap_b32 v50, v51
    v_max_f32 v48, v48, v49
    v_max_f32 v50, v50, v51
    v_mov_b32 v49, v48
    v_mov_b32 v51, v50
    s_nop 0
    v_permlane32_swap_b32 v48, v49
    v_permlane32_swap_b32 v50, v51
    v_max_f32 v48, v48, v49
    v_max_f32 v50, v50, v51
    v_sub_f32 v49, v44, v48
    v_sub_f32 v51, v46, v50
    v_mul_f32 v49, s76, v49
    v_mul_f32 v51, s76, v51
    v_exp_f32 v49, v49
    v_exp_f32 v51, v51
    v_mul_f32 v44, 0x3e000000, v48
    v_mul_f32 v46, 0x3e000000, v50
    v_mul_f32 v45, v45, v49
    v_mul_f32 v47, v47, v51
    v_readlane_b32 s9, v49, s8
    v_readlane_b32 s8, v51, s8
    v_permlane32_swap_b32 v44, v46
    v_permlane32_swap_b32 v45, v47
    v_add_f32 v44, v44, v46
    v_add_f32 v45, v45, v47
    s_nop 1
    v_permlane16_swap_b32 v44, v45
    v_add_f32 v44, v44, v45
    v_mov_b32 v48, s9
    v_mov_b32 v49, s8
    v_add_f32_dpp v44, v44, v44 row_ror:8 row_mask:0xf bank_mask:0xf
    v_cndmask_b32 v48, v48, v49, s[90:91]
    v_bfi_b32 v44, s72, v202, v44
    s_mov_b64 exec, s[10:11]
    s_cmp_eq_u32 s74, 0
    s_cbranch_scc1 L_ls25
    buffer_store_dword v44, v19, s[44:47], s12 offen
    s_branch L_le26
L_ls25:
    buffer_store_dword v44, v19, s[44:47], s12 offen sc1
L_le26:
    s_mov_b64 exec, -1
    s_waitcnt vmcnt(7)
    v_mfma_f32_16x16x32_bf16 v[40:43], v[76:79], v[108:111], v[40:43]
    s_waitcnt vmcnt(6)
    v_mfma_f32_16x16x32_bf16 v[40:43], v[80:83], v[112:115], v[40:43]
    s_waitcnt vmcnt(5)
    v_mfma_f32_16x16x32_bf16 v[40:43], v[84:87], v[116:119], v[40:43]
    s_waitcnt vmcnt(4)
    v_mfma_f32_16x16x32_bf16 v[40:43], v[88:91], v[120:123], v[40:43]
    s_waitcnt vmcnt(3)
    v_mfma_f32_16x16x32_bf16 v[40:43], v[92:95], v[124:127], v[40:43]
    s_nop 7
    v_mul_f32 v40, v40, v48
    v_mul_f32 v41, v41, v48
    v_mul_f32 v42, v42, v48
    v_mul_f32 v43, v43, v48
    ds_write2_b32 v22, v40, v41 offset0:0 offset1:4
    ds_write2_b32 v22, v42, v43 offset0:8 offset1:12
    s_waitcnt lgkmcnt(0)
    s_barrier
    ds_read_b128 v[40:43], v23 offset:5120
    s_waitcnt lgkmcnt(0)
    v_permlane32_swap_b32 v40, v42
    v_permlane32_swap_b32 v41, v43
    v_add_f32 v40, v40, v42
    v_add_f32 v41, v41, v43
    s_nop 1
    v_permlane16_swap_b32 v40, v41
    v_add_f32 v40, v40, v41
    s_nop 1
    v_add_f32_dpp v40, v40, v40 row_ror:8 row_mask:0xf bank_mask:0xf
    v_bfi_b32 v40, s72, v216, v40
    s_mov_b64 exec, s[84:85]
    s_cmp_eq_u32 s74, 0
    s_cbranch_scc1 L_ls27
    buffer_store_dword v40, v20, s[44:47], s13 offen
    s_branch L_le28
L_ls27:
    buffer_store_dword v40, v20, s[44:47], s13 offen sc1
L_le28:
    s_mov_b64 exec, -1
    s_mov_b32 s70, 0x05040100
    s_mov_b32 s82, 0xffff0000
    s_mov_b32 s83, 0xffff0000
    s_waitcnt vmcnt(6)
    v_perm_b32 v64, v132, v128, s70
    v_perm_b32 v68, v132, v128, s75
    v_perm_b32 v72, v133, v129, s70
    v_perm_b32 v76, v133, v129, s75
    v_perm_b32 v80, v134, v130, s70
    v_perm_b32 v84, v134, v130, s75
    v_perm_b32 v88, v135, v131, s70
    v_perm_b32 v92, v135, v131, s75
    s_waitcnt vmcnt(4)
    v_perm_b32 v65, v140, v136, s70
    v_perm_b32 v69, v140, v136, s75
    v_perm_b32 v73, v141, v137, s70
    v_perm_b32 v77, v141, v137, s75
    v_perm_b32 v81, v142, v138, s70
    v_perm_b32 v85, v142, v138, s75
    v_perm_b32 v89, v143, v139, s70
    v_perm_b32 v93, v143, v139, s75
    s_waitcnt vmcnt(2)
    v_perm_b32 v66, v148, v144, s70
    v_perm_b32 v70, v148, v144, s75
    v_perm_b32 v74, v149, v145, s70
    v_perm_b32 v78, v149, v145, s75
    v_perm_b32 v82, v150, v146, s70
    v_perm_b32 v86, v150, v146, s75
    v_perm_b32 v90, v151, v147, s70
    v_perm_b32 v94, v151, v147, s75
    s_waitcnt vmcnt(0)
    v_perm_b32 v67, v156, v152, s70
    v_perm_b32 v71, v156, v152, s75
    v_perm_b32 v75, v157, v153, s70
    v_perm_b32 v79, v157, v153, s75
    v_perm_b32 v83, v158, v154, s70
    v_perm_b32 v87, v158, v154, s75
    v_perm_b32 v91, v159, v155, s70
    v_perm_b32 v95, v159, v155, s75
    v_lshrrev_b32 v16, 3, v0
    v_and_b32 v17, 0x70, v1
    v_mul_u32_u24 v16, 1152, v16
    v_lshl_add_u32 v12, v16, 3, v17
    v_add_u32 v16, 64512, v16
    v_add_u32 v13, v16, v17
    s_lshl_b32 s8, s3, 5
    s_lshr_b32 s9, s5, 2
    s_lshl_b32 s9, s9, 4
    s_add_u32 s8, s8, s9
    s_mul_i32 s8, s8, 1152
    s_add_u32 s8, s8, 458752
    s_and_b32 s9, s5, 3
    s_lshl_b32 s9, s9, 8
    s_add_u32 s9, s9, s8
    v_lshrrev_b32 v16, 4, v0
    v_mul_u32_u24 v17, 4608, v16
    v_and_b32 v18, 0xf0, v1
    v_add_u32 v26, v17, v18
    v_lshl_add_u32 v17, v16, 2, v0
    v_and_b32 v17, 15, v17
    v_lshlrev_b32 v27, 4, v17
    s_lshl_b32 s68, s3, 1
    s_lshr_b32 s69, s5, 2
    s_add_u32 s68, s68, s69
    s_lshl_b32 s68, s68, 8
    s_add_u32 s68, s68, 1024000
    s_mul_i32 s10, s3, 2304
    s_lshl_b32 s11, s6, 8
    s_add_u32 s13, s10, s11
    s_add_u32 s12, s13, 786432
    s_mov_b32 s64, s8
    s_mul_i32 s8, s5, 272
    v_and_b32 v16, 32, v0
    v_and_b32 v17, 7, v0
    v_lshl_add_u32 v16, v17, 1, v16
    v_bfe_u32 v17, v0, 4, 1
    v_add_lshl_u32 v16, v16, v17, 2
    v_add_u32 v204, s8, v16
    v_add_u32 v211, 64, v204
    s_mov_b32 s8, s64
    s_bitcmp1_b32 s5, 1
    s_cselect_b64 s[10:11], -1, 0
    s_mov_b64 s[96:97], -1
    s_mov_b64 s[98:99], -1
    s_mov_b64 s[100:101], -1
    s_mov_b64 s[78:79], -1
    s_mov_b64 s[80:81], -1
    s_mov_b32 s7, 0
L_mp29:
    s_mov_b64 exec, s[96:97]
    s_cbranch_execz L_ms31
    buffer_load_dwordx4 v[32:35], v26, s[44:47], s9 offen offset:0 sc1
L_ms31:
    s_mov_b64 exec, s[98:99]
    s_cbranch_execz L_ms32
    buffer_load_dwordx4 v[36:39], v26, s[44:47], s9 offen offset:1152 sc1
L_ms32:
    s_mov_b64 exec, s[100:101]
    s_cbranch_execz L_ms33
    buffer_load_dwordx4 v[40:43], v26, s[44:47], s9 offen offset:2304 sc1
L_ms33:
    s_mov_b64 exec, s[78:79]
    s_cbranch_execz L_ms34
    buffer_load_dwordx4 v[44:47], v26, s[44:47], s9 offen offset:3456 sc1
L_ms34:
    s_mov_b64 exec, s[80:81]
    s_cbranch_execz L_ms35
    buffer_load_dwordx4 v[48:51], v27, s[44:47], s68 offen sc1
L_ms35:
    s_add_u32 s7, s7, 1
    s_cmp_gt_u32 s7, 400000
    s_cbranch_scc1 L_end
    s_waitcnt vmcnt(0)
    s_mov_b64 exec, s[96:97]
    s_cbranch_execz L_mc36
    v_xor_b32 v32, v32, v6
    v_xor_b32 v33, v33, v7
    v_xor_b32 v34, v34, v8
    v_xor_b32 v35, v35, v9
    v_or3_b32 v236, v32, v33, v34
    v_bitop3_b32 v21, v35, v236, s72 bitop3:0xa8
    v_cmp_ne_u32 s[96:97], 0, v21
L_mc36:
    s_mov_b64 exec, s[98:99]
    s_cbranch_execz L_mc37
    v_xor_b32 v36, v36, v6
    v_xor_b32 v37, v37, v7
    v_xor_b32 v38, v38, v8
    v_xor_b32 v39, v39, v9
    v_or3_b32 v236, v36, v37, v38
    v_bitop3_b32 v21, v39, v236, s72 bitop3:0xa8
    v_cmp_ne_u32 s[98:99], 0, v21
L_mc37:
    s_mov_b64 exec, s[100:101]
    s_cbranch_execz L_mc38
    v_xor_b32 v40, v40, v6
    v_xor_b32 v41, v41, v7
    v_xor_b32 v42, v42, v8
    v_xor_b32 v43, v43, v9
    v_or3_b32 v236, v40, v41, v42
    v_bitop3_b32 v21, v43, v236, s72 bitop3:0xa8
    v_cmp_ne_u32 s[100:101], 0, v21
L_mc38:
    s_mov_b64 exec, s[78:79]
    s_cbranch_execz L_mc39
    v_xor_b32 v44, v44, v6
    v_xor_b32 v45, v45, v7
    v_xor_b32 v46, v46, v8
    v_xor_b32 v47, v47, v9
    v_or3_b32 v236, v44, v45, v46
    v_bitop3_b32 v21, v47, v236, s72 bitop3:0xa8
    v_cmp_ne_u32 s[78:79], 0, v21
L_mc39:
    s_mov_b64 exec, s[80:81]
    s_cbranch_execz L_mc40
    v_xor_b32 v48, v48, v6
    v_xor_b32 v49, v49, v7
    v_xor_b32 v50, v50, v8
    v_xor_b32 v51, v51, v9
    v_or3_b32 v236, v48, v49, v50
    v_bitop3_b32 v21, v51, v236, s72 bitop3:0xa8
    v_cmp_ne_u32 s[80:81], 0, v21
L_mc40:
    s_cmp_lg_u64 s[80:81], 0
    s_mov_b64 exec, -1
    s_cbranch_scc1 L_mp29
L_md30:
    v_cndmask_b32 v28, v48, v50, s[10:11]
    v_cndmask_b32 v29, v49, v51, s[10:11]
    s_nop 0
    v_max_f32_dpp v30, v28, v28 row_ror:8 row_mask:0xf bank_mask:0xf
    s_nop 1
    v_max_f32_dpp v30, v30, v30 row_ror:4 row_mask:0xf bank_mask:0xf
    s_nop 1
    v_max_f32_dpp v30, v30, v30 row_ror:2 row_mask:0xf bank_mask:0xf
    s_nop 1
    v_max_f32_dpp v30, v30, v30 row_ror:1 row_mask:0xf bank_mask:0xf
    v_sub_f32 v28, v28, v30
    v_mul_f32 v28, s76, v28
    v_exp_f32 v28, v28
    s_nop 0
    v_mul_f32 v29, v28, v29
    s_nop 1
    v_add_f32_dpp v29, v29, v29 row_ror:8 row_mask:0xf bank_mask:0xf
    s_nop 1
    v_add_f32_dpp v29, v29, v29 row_ror:4 row_mask:0xf bank_mask:0xf
    s_nop 1
    v_add_f32_dpp v29, v29, v29 row_ror:2 row_mask:0xf bank_mask:0xf
    s_nop 1
    v_add_f32_dpp v29, v29, v29 row_ror:1 row_mask:0xf bank_mask:0xf
    v_rcp_f32 v29, v29
    s_nop 0
    v_mul_f32 v28, v28, v29
    s_or_b64 vcc, s[96:97], s[98:99]
    s_or_b64 vcc, vcc, s[100:101]
    s_or_b64 vcc, vcc, s[78:79]
    s_cbranch_scc0 L_md42
    s_mov_b32 s7, 0
L_mp41:
    s_mov_b64 exec, s[96:97]
    s_cbranch_execz L_ms43
    buffer_load_dwordx4 v[32:35], v26, s[44:47], s9 offen offset:0 sc1
L_ms43:
    s_mov_b64 exec, s[98:99]
    s_cbranch_execz L_ms44
    buffer_load_dwordx4 v[36:39], v26, s[44:47], s9 offen offset:1152 sc1
L_ms44:
    s_mov_b64 exec, s[100:101]
    s_cbranch_execz L_ms45
    buffer_load_dwordx4 v[40:43], v26, s[44:47], s9 offen offset:2304 sc1
L_ms45:
    s_mov_b64 exec, s[78:79]
    s_cbranch_execz L_ms46
    buffer_load_dwordx4 v[44:47], v26, s[44:47], s9 offen offset:3456 sc1
L_ms46:
    s_add_u32 s7, s7, 1
    s_cmp_gt_u32 s7, 400000
    s_cbranch_scc1 L_end
    s_waitcnt vmcnt(0)
    s_mov_b64 exec, s[96:97]
    s_cbranch_execz L_mc47
    v_xor_b32 v32, v32, v6
    v_xor_b32 v33, v33, v7
    v_xor_b32 v34, v34, v8
    v_xor_b32 v35, v35, v9
    v_or3_b32 v236, v32, v33, v34
    v_bitop3_b32 v21, v35, v236, s72 bitop3:0xa8
    v_cmp_ne_u32 s[96:97], 0, v21
L_mc47:
    s_mov_b64 exec, s[98:99]
    s_cbranch_execz L_mc48
    v_xor_b32 v36, v36, v6
    v_xor_b32 v37, v37, v7
    v_xor_b32 v38, v38, v8
    v_xor_b32 v39, v39, v9
    v_or3_b32 v236, v36, v37, v38
    v_bitop3_b32 v21, v39, v236, s72 bitop3:0xa8
    v_cmp_ne_u32 s[98:99], 0, v21
L_mc48:
    s_mov_b64 exec, s[100:101]
    s_cbranch_execz L_mc49
    v_xor_b32 v40, v40, v6
    v_xor_b32 v41, v41, v7
    v_xor_b32 v42, v42, v8
    v_xor_b32 v43, v43, v9
    v_or3_b32 v236, v40, v41, v42
    v_bitop3_b32 v21, v43, v236, s72 bitop3:0xa8
    v_cmp_ne_u32 s[100:101], 0, v21
L_mc49:
    s_mov_b64 exec, s[78:79]
    s_cbranch_execz L_mc50
    v_xor_b32 v44, v44, v6
    v_xor_b32 v45, v45, v7
    v_xor_b32 v46, v46, v8
    v_xor_b32 v47, v47, v9
    v_or3_b32 v236, v44, v45, v46
    v_bitop3_b32 v21, v47, v236, s72 bitop3:0xa8
    v_cmp_ne_u32 s[78:79], 0, v21
L_mc50:
    s_or_b64 vcc, s[96:97], s[98:99]
    s_or_b64 vcc, vcc, s[100:101]
    s_or_b64 vcc, vcc, s[78:79]
    s_mov_b64 exec, -1
    s_cbranch_scc1 L_mp41
L_md42:
    v_mul_f32_dpp v52, v28, v32 row_newbcast:0 row_mask:0xf bank_mask:0xf
    v_mul_f32_dpp v53, v28, v33 row_newbcast:0 row_mask:0xf bank_mask:0xf
    v_mul_f32_dpp v54, v28, v34 row_newbcast:0 row_mask:0xf bank_mask:0xf
    v_mul_f32_dpp v55, v28, v35 row_newbcast:0 row_mask:0xf bank_mask:0xf
    v_fmac_f32_dpp v52, v28, v36 row_newbcast:1 row_mask:0xf bank_mask:0xf
    v_fmac_f32_dpp v53, v28, v37 row_newbcast:1 row_mask:0xf bank_mask:0xf
    v_fmac_f32_dpp v54, v28, v38 row_newbcast:1 row_mask:0xf bank_mask:0xf
    v_fmac_f32_dpp v55, v28, v39 row_newbcast:1 row_mask:0xf bank_mask:0xf
    v_fmac_f32_dpp v52, v28, v40 row_newbcast:2 row_mask:0xf bank_mask:0xf
    v_fmac_f32_dpp v53, v28, v41 row_newbcast:2 row_mask:0xf bank_mask:0xf
    v_fmac_f32_dpp v54, v28, v42 row_newbcast:2 row_mask:0xf bank_mask:0xf
    v_fmac_f32_dpp v55, v28, v43 row_newbcast:2 row_mask:0xf bank_mask:0xf
    v_fmac_f32_dpp v52, v28, v44 row_newbcast:3 row_mask:0xf bank_mask:0xf
    v_fmac_f32_dpp v53, v28, v45 row_newbcast:3 row_mask:0xf bank_mask:0xf
    v_fmac_f32_dpp v54, v28, v46 row_newbcast:3 row_mask:0xf bank_mask:0xf
    v_fmac_f32_dpp v55, v28, v47 row_newbcast:3 row_mask:0xf bank_mask:0xf
    s_nop 0
    v_permlane32_swap_b32 v52, v54
    v_permlane32_swap_b32 v53, v55
    v_add_f32 v52, v52, v54
    v_add_f32 v53, v53, v55
    s_nop 1
    v_permlane16_swap_b32 v52, v53
    v_add_f32 v52, v52, v53
    s_nop 1
    v_mov_b32_dpp v46, v52 quad_perm:[1,0,3,2] row_mask:0xf bank_mask:0xf
    v_cvt_pk_bf16_f32 v47, v52, v46
    ds_swizzle_b32 v48, v47 offset:24
    ds_swizzle_b32 v49, v47 offset:88
    ds_swizzle_b32 v50, v47 offset:152
    ds_swizzle_b32 v51, v47 offset:216
    s_waitcnt lgkmcnt(0)
    v_mfma_f32_16x16x32_bf16 v[96:99], v[48:51], v[64:67], 0
    v_mfma_f32_16x16x32_bf16 v[112:115], v[48:51], v[80:83], 0
    v_mfma_f32_16x16x32_bf16 v[104:107], v[48:51], v[72:75], 0
    v_mfma_f32_16x16x32_bf16 v[120:123], v[48:51], v[88:91], 0
    v_mfma_f32_16x16x32_bf16 v[100:103], v[48:51], v[68:71], 0
    v_mfma_f32_16x16x32_bf16 v[116:119], v[48:51], v[84:87], 0
    v_mfma_f32_16x16x32_bf16 v[108:111], v[48:51], v[76:79], 0
    v_mfma_f32_16x16x32_bf16 v[124:127], v[48:51], v[92:95], 0
    s_nop 1
    v_cndmask_b32 v40, v96, v112, s[82:83]
    s_nop 0
    v_cndmask_b32 v42, v106, v122, s[82:83]
    s_nop 0
    v_cndmask_b32 v41, v101, v117, s[82:83]
    s_nop 0
    v_cndmask_b32 v43, v111, v127, s[82:83]
    v_permlane32_swap_b32 v40, v42
    s_nop 0
    v_permlane32_swap_b32 v41, v43
    v_add_f32_dpp v40, v42, v40 row_ror:8 row_mask:0xf bank_mask:0xf
    s_nop 0
    v_add_f32_dpp v41, v43, v41 row_ror:8 row_mask:0xf bank_mask:0xf
    s_mov_b64 exec, s[84:85]
    ds_write_b32 v204, v40 offset:0
    ds_write_b32 v211, v41 offset:0
    s_mov_b64 exec, -1
    s_waitcnt lgkmcnt(0)
    s_barrier
    s_cmp_lg_u32 s5, 0
    s_cbranch_scc1 L_ap51
    ds_read_b128 v[16:19], v208 offset:0
    ds_read_b128 v[20:23], v208 offset:1088
    s_waitcnt lgkmcnt(0)
    v_pk_add_f32 v[16:17], v[16:17], v[20:21]
    v_pk_add_f32 v[18:19], v[18:19], v[22:23]
    s_nop 1
    v_permlane32_swap_b32 v16, v18
    v_permlane32_swap_b32 v17, v19
    v_pk_add_f32 v[16:17], v[16:17], v[18:19]
    s_nop 1
    v_permlane16_swap_b32 v16, v17
    v_add_f32 v16, v16, v17
    v_bfi_b32 v16, s72, v216, v16
    buffer_store_dword v16, v234, s[44:47], s12 offen sc1
L_ap51:
    s_barrier
    buffer_load_dwordx4 v[164:167], v12, s[60:63], s15 offen nt
    s_add_u32 s15, s15, 1152
    buffer_load_dwordx4 v[168:171], v12, s[60:63], s15 offen nt
    s_add_u32 s15, s15, 1152
    buffer_load_dwordx4 v[172:175], v12, s[60:63], s15 offen nt
    s_add_u32 s15, s15, 1152
    buffer_load_dwordx4 v[176:179], v12, s[60:63], s15 offen nt
    s_add_u32 s15, s15, 1152
    buffer_load_dwordx4 v[180:183], v12, s[60:63], s15 offen nt
    s_add_u32 s15, s15, 1152
    buffer_load_dwordx4 v[184:187], v12, s[60:63], s15 offen nt
    s_add_u32 s15, s15, 1152
    buffer_load_dwordx4 v[188:191], v12, s[60:63], s15 offen nt
    s_add_u32 s15, s15, 1152
    buffer_load_dwordx4 v[192:195], v12, s[60:63], s15 offen nt
    s_add_u32 s15, s15, 1152
    buffer_load_dwordx4 v[196:199], v13, s[60:63], s15 offen nt
    s_add_u32 s15, s15, 1152
    s_mov_b32 s70, 0x05040100
    s_mov_b32 s82, 0xffff0000
    s_mov_b32 s83, 0xffff0000
    s_waitcnt vmcnt(7)
    v_perm_b32 v64, v168, v164, s70
    v_perm_b32 v68, v168, v164, s75
    v_perm_b32 v72, v169, v165, s70
    v_perm_b32 v76, v169, v165, s75
    v_perm_b32 v80, v170, v166, s70
    v_perm_b32 v84, v170, v166, s75
    v_perm_b32 v88, v171, v167, s70
    v_perm_b32 v92, v171, v167, s75
    s_waitcnt vmcnt(5)
    v_perm_b32 v65, v176, v172, s70
    v_perm_b32 v69, v176, v172, s75
    v_perm_b32 v73, v177, v173, s70
    v_perm_b32 v77, v177, v173, s75
    v_perm_b32 v81, v178, v174, s70
    v_perm_b32 v85, v178, v174, s75
    v_perm_b32 v89, v179, v175, s70
    v_perm_b32 v93, v179, v175, s75
    s_waitcnt vmcnt(3)
    v_perm_b32 v66, v184, v180, s70
    v_perm_b32 v70, v184, v180, s75
    v_perm_b32 v74, v185, v181, s70
    v_perm_b32 v78, v185, v181, s75
    v_perm_b32 v82, v186, v182, s70
    v_perm_b32 v86, v186, v182, s75
    v_perm_b32 v90, v187, v183, s70
    v_perm_b32 v94, v187, v183, s75
    s_waitcnt vmcnt(1)
    v_perm_b32 v67, v192, v188, s70
    v_perm_b32 v71, v192, v188, s75
    v_perm_b32 v75, v193, v189, s70
    v_perm_b32 v79, v193, v189, s75
    v_perm_b32 v83, v194, v190, s70
    v_perm_b32 v87, v194, v190, s75
    v_perm_b32 v91, v195, v191, s70
    v_perm_b32 v95, v195, v191, s75
    s_mul_i32 s8, s3, 9216
    s_mul_i32 s9, s5, 576
    s_add_u32 s8, s8, s9
    s_add_u32 s8, s8, 1572864
    s_add_u32 s9, s8, 4608
    v_lshlrev_b32 v26, 3, v0
    v_and_b32 v27, 0x38, v0
    v_mov_b32 v38, 0x3d372713
    s_add_u32 s12, s13, 917504
    s_mul_i32 s8, s3, 9216
    s_mul_i32 s9, s5, 288
    s_add_u32 s8, s8, s9
    s_add_u32 s8, s8, 1572864
    v_lshrrev_b32 v27, 1, v27
    s_mov_b32 s7, 0
L_poll52:
    buffer_load_dword v58, v234, s[44:47], s8 offen sc1
    buffer_load_dword v59, v27, s[44:47], s8 offen offset:256 sc1
    buffer_load_dword v60, v234, s[44:47], s8 offen offset:2304 sc1
    buffer_load_dword v61, v27, s[44:47], s8 offen offset:2560 sc1
    s_add_u32 s7, s7, 1
    s_cmp_gt_u32 s7, 400000
    s_cbranch_scc1 L_end
    s_waitcnt vmcnt(0)
    v_bitop3_b32 v236, v60, v58, v216 bitop3:0x7e
    v_bitop3_b32 v237, v61, v59, v217 bitop3:0x7e
    v_bitop3_b32 v21, v236, v237, s72 bitop3:0xa8
    v_cmp_ne_u32 vcc, 0, v21
    s_cbranch_vccnz L_poll52
    v_and_b32 v32, s73, v58
    v_and_b32 v33, s73, v59
    v_and_b32 v34, s73, v60
    v_and_b32 v35, s73, v61
    v_mul_f32 v36, v32, v32
    v_mul_f32 v37, v33, v33
    v_fma_f32 v36, v36, v38, 1.0
    v_fma_f32 v37, v37, v38, 1.0
    v_mul_f32 v36, v36, v32
    v_mul_f32 v37, v37, v33
    v_mul_f32 v36, 0xc0135761, v36
    v_mul_f32 v37, 0xc0135761, v37
    v_exp_f32 v36, v36
    v_exp_f32 v37, v37
    v_mul_f32 v32, v32, v34
    v_mul_f32 v33, v33, v35
    v_add_f32 v36, 1.0, v36
    v_add_f32 v37, 1.0, v37
    v_rcp_f32 v36, v36
    v_rcp_f32 v37, v37
    v_mul_f32 v32, v32, v36
    v_mul_f32 v33, v33, v37
    s_nop 0
    v_mov_b32_dpp v46, v32 quad_perm:[1,0,3,2] row_mask:0xf bank_mask:0xf
    v_cvt_pk_bf16_f32 v56, v33, v33
    v_cvt_pk_bf16_f32 v47, v32, v46
    ds_swizzle_b32 v48, v47 offset:24
    ds_swizzle_b32 v49, v47 offset:88
    ds_swizzle_b32 v50, v47 offset:152
    ds_swizzle_b32 v51, v47 offset:216
    v_and_b32 v52, v56, v2
    v_and_b32 v53, v56, v3
    v_and_b32 v54, v56, v4
    v_and_b32 v55, v56, v5
    s_nop 1
    v_mfma_f32_16x16x32_bf16 v[40:43], v[52:55], v[196:199], 0
    s_waitcnt lgkmcnt(0)
    v_mfma_f32_16x16x32_bf16 v[96:99], v[48:51], v[64:67], v[40:43]
    v_mfma_f32_16x16x32_bf16 v[112:115], v[48:51], v[80:83], v[40:43]
    v_mfma_f32_16x16x32_bf16 v[104:107], v[48:51], v[72:75], v[40:43]
    v_mfma_f32_16x16x32_bf16 v[120:123], v[48:51], v[88:91], v[40:43]
    v_mfma_f32_16x16x32_bf16 v[100:103], v[48:51], v[68:71], v[40:43]
    v_mfma_f32_16x16x32_bf16 v[116:119], v[48:51], v[84:87], v[40:43]
    v_mfma_f32_16x16x32_bf16 v[108:111], v[48:51], v[76:79], v[40:43]
    v_mfma_f32_16x16x32_bf16 v[124:127], v[48:51], v[92:95], v[40:43]
    s_nop 2
    v_cndmask_b32 v40, v96, v112, s[82:83]
    v_cndmask_b32 v42, v106, v122, s[82:83]
    s_nop 0
    v_cndmask_b32 v41, v101, v117, s[82:83]
    s_nop 0
    v_cndmask_b32 v43, v111, v127, s[82:83]
    v_permlane32_swap_b32 v40, v42
    s_nop 0
    v_permlane32_swap_b32 v41, v43
    v_add_f32_dpp v40, v42, v40 row_ror:8 row_mask:0xf bank_mask:0xf
    s_nop 0
    v_add_f32_dpp v41, v43, v41 row_ror:8 row_mask:0xf bank_mask:0xf
    s_mov_b64 exec, s[84:85]
    ds_write_b32 v204, v40 offset:2304
    ds_write_b32 v211, v41 offset:2304
    s_mov_b64 exec, -1
    s_waitcnt lgkmcnt(0)
    s_barrier
    s_cmp_lg_u32 s5, 0
    s_cbranch_scc1 L_ap53
    ds_read_b128 v[16:19], v208 offset:2304
    ds_read_b128 v[20:23], v208 offset:3392
    s_waitcnt lgkmcnt(0)
    v_pk_add_f32 v[16:17], v[16:17], v[20:21]
    v_pk_add_f32 v[18:19], v[18:19], v[22:23]
    s_nop 1
    v_permlane32_swap_b32 v16, v18
    v_permlane32_swap_b32 v17, v19
    v_pk_add_f32 v[16:17], v[16:17], v[18:19]
    s_nop 1
    v_permlane16_swap_b32 v16, v17
    v_add_f32 v16, v16, v17
    v_bfi_b32 v16, s72, v216, v16
    buffer_store_dword v16, v234, s[44:47], s12 offen sc1
L_ap53:
    s_branch L_fin
L_MR:
    s_sub_u32 s6, s4, 27
    s_lshl_b32 s6, s6, 3
    s_add_u32 s6, s6, s3
    s_mov_b32 s64, s34
    s_mov_b32 s65, s35
    s_mov_b32 s66, 1152
    s_mov_b32 s67, 0x20000
    s_mov_b32 s56, s36
    s_mov_b32 s57, s37
    s_mov_b32 s58, 3981312
    s_mov_b32 s59, 0x20000
    s_cmp_ge_u32 s6, 36
    s_cselect_b32 s58, 0, s58
    v_lshrrev_b32 v16, 3, v0
    v_mul_u32_u24 v17, 10, v16
    v_and_b32 v18, 7, v0
    v_lshl_add_u32 v17, v18, 1, v17
    s_mul_i32 s8, s5, 80
    buffer_load_ushort v30, v17, s[64:67], s8 offen
    v_mul_u32_u24 v16, 34560, v16
    v_lshl_add_u32 v12, v18, 4, v16
    s_mul_i32 s14, s5, 276480
    s_lshl_b32 s8, s6, 7
    s_add_u32 s14, s14, s8
    s_add_u32 s14, s14, 2304
    buffer_load_dwordx4 v[128:131], v12, s[56:59], s14 offen nt
    s_add_u32 s14, s14, 6912
    buffer_load_dwordx4 v[132:135], v12, s[56:59], s14 offen nt
    s_add_u32 s14, s14, 6912
    s_waitcnt vmcnt(4)
    buffer_load_dwordx4 v[136:139], v12, s[56:59], s14 offen nt
    s_add_u32 s14, s14, 6912
    s_waitcnt vmcnt(4)
    buffer_load_dwordx4 v[140:143], v12, s[56:59], s14 offen nt
    s_add_u32 s14, s14, 6912
    s_waitcnt vmcnt(4)
    v_lshlrev_b32 v30, 16, v30
    v_mul_f32 v33, 0xbfb8aa3b, v30
    v_exp_f32 v33, v33
    s_nop 0
    v_add_f32 v33, 1.0, v33
    v_min_f32 v33, 0x7e800000, v33
    v_rcp_f32 v34, v33
    s_nop 0
    v_mul_f32 v35, v30, v34
    v_fma_f32 v33, -v33, v35, v30
    v_fma_f32 v30, v33, v34, v35
    v_cvt_pk_bf16_f32 v30, v30, v30
    ds_swizzle_b32 v48, v30 offset:24
    ds_swizzle_b32 v49, v30 offset:56
    ds_swizzle_b32 v50, v30 offset:88
    ds_swizzle_b32 v51, v30 offset:120
    ds_swizzle_b32 v52, v30 offset:152
    s_cmp_lg_u32 s5, 3
    s_cbranch_scc1 L_tch54
    v_lshlrev_b32 v17, 7, v0
    s_lshl_b32 s8, s3, 5
    s_add_u32 s8, s8, s4
    s_mul_i32 s8, s8, 1152
    s_add_u32 s8, s8, 458752
    s_mov_b32 exec_lo, 255
    s_mov_b32 exec_hi, 0
    buffer_load_dword v205, v17, s[44:47], s8 offen sc1
    s_mul_i32 s8, s3, 2304
    s_add_u32 s8, s8, 950272
    s_mov_b32 exec_lo, 262143
    s_mov_b32 exec_hi, 0
    buffer_load_dword v205, v17, s[44:47], s8 offen sc1
    s_mul_i32 s8, s3, 6912
    s_add_u32 s8, s8, 1703936
    s_mov_b32 exec_lo, 4294967295
    s_mov_b32 exec_hi, 8191
    buffer_load_dword v205, v17, s[44:47], s8 offen sc1
    s_mov_b64 exec, -1
L_tch54:
    s_waitcnt lgkmcnt(0)
    s_waitcnt vmcnt(3)
    buffer_load_dwordx4 v[144:147], v12, s[56:59], s14 offen nt
    s_add_u32 s14, s14, 6912
    s_waitcnt vmcnt(3)
    s_add_u32 s77, s94, 737280
    s_and_b32 s77, s77, 0xfffff
    buffer_load_dwordx4 v[72:75], v14, s[48:51], s77 offen nt
    s_waitcnt vmcnt(3)
    s_add_u32 s77, s94, 1105920
    s_and_b32 s77, s77, 0xfffff
    buffer_load_dwordx4 v[76:79], v14, s[48:51], s77 offen nt
    s_waitcnt vmcnt(3)
    s_add_u32 s77, s94, 1474560
    s_and_b32 s77, s77, 0xfffff
    buffer_load_dwordx4 v[80:83], v14, s[48:51], s77 offen nt
    s_waitcnt vmcnt(3)
    s_add_u32 s77, s94, 1843200
    s_and_b32 s77, s77, 0xfffff
    buffer_load_dwordx4 v[84:87], v14, s[48:51], s77 offen nt
    s_waitcnt vmcnt(4)
    v_and_b32 v32, v48, v2
    v_and_b32 v33, v48, v3
    v_and_b32 v34, v48, v4
    v_and_b32 v35, v48, v5
    v_and_b32 v36, v49, v2
    v_and_b32 v37, v49, v3
    v_and_b32 v38, v49, v4
    v_and_b32 v39, v49, v5
    v_mfma_f32_16x16x32_bf16 v[40:43], v[32:35], v[128:131], 0
    v_and_b32 v32, v50, v2
    v_and_b32 v33, v50, v3
    v_and_b32 v34, v50, v4
    v_and_b32 v35, v50, v5
    v_mfma_f32_16x16x32_bf16 v[40:43], v[36:39], v[132:135], v[40:43]
    v_and_b32 v36, v51, v2
    v_and_b32 v37, v51, v3
    v_and_b32 v38, v51, v4
    v_and_b32 v39, v51, v5
    v_mfma_f32_16x16x32_bf16 v[40:43], v[32:35], v[136:139], v[40:43]
    v_and_b32 v32, v52, v2
    v_and_b32 v33, v52, v3
    v_and_b32 v34, v52, v4
    v_and_b32 v35, v52, v5
    v_mfma_f32_16x16x32_bf16 v[40:43], v[36:39], v[140:143], v[40:43]
    s_nop 0
    v_mfma_f32_16x16x32_bf16 v[40:43], v[32:35], v[144:147], v[40:43]
    s_nop 7
    v_permlane32_swap_b32 v40, v42
    v_permlane32_swap_b32 v41, v43
    s_nop 0
    v_add_f32_dpp v40, v42, v40 row_ror:8 row_mask:0xf bank_mask:0xf
    v_add_f32_dpp v41, v43, v41 row_ror:8 row_mask:0xf bank_mask:0xf
    s_mov_b64 exec, s[84:85]
    ds_write_b32 v204, v40 offset:0
    ds_write_b32 v211, v41 offset:0
    s_mov_b64 exec, -1
    s_waitcnt lgkmcnt(0)
    s_barrier
    s_cmp_ge_u32 s6, 36
    s_cbranch_scc1 L_mri55
    s_lshl_b32 s8, s6, 8
    s_add_u32 s8, s8, 1835008
    s_cmp_lg_u32 s5, 0
    s_cbranch_scc1 L_ap56
    ds_read_b128 v[16:19], v208 offset:0
    ds_read_b128 v[20:23], v208 offset:1088
    s_waitcnt lgkmcnt(0)
    v_pk_add_f32 v[16:17], v[16:17], v[20:21]
    v_pk_add_f32 v[18:19], v[18:19], v[22:23]
    s_nop 1
    v_permlane32_swap_b32 v16, v18
    v_permlane32_swap_b32 v17, v19
    v_pk_add_f32 v[16:17], v[16:17], v[18:19]
    s_nop 1
    v_permlane16_swap_b32 v16, v17
    v_add_f32 v16, v16, v17
    v_bfi_b32 v16, s72, v216, v16
    buffer_store_dword v16, v234, s[44:47], s8 offen sc1
L_ap56:
L_mri55:
    s_waitcnt vmcnt(3)
    s_add_u32 s77, s94, 2211840
    s_and_b32 s77, s77, 0xfffff
    buffer_load_dwordx4 v[88:91], v14, s[48:51], s77 offen nt
    s_waitcnt vmcnt(3)
    s_add_u32 s77, s94, 2580480
    s_and_b32 s77, s77, 0xfffff
    buffer_load_dwordx4 v[92:95], v14, s[48:51], s77 offen nt
    s_mul_i32 s9, s3, 36864
    s_lshr_b32 s10, s4, 4
    s_lshl_b32 s10, s10, 10
    s_add_u32 s9, s9, s10
    s_lshl_b32 s10, s5, 7
    s_add_u32 s9, s9, s10
    s_add_u32 s9, s9, 65536
    s_add_u32 s11, s9, 16384
    s_add_u32 s64, s9, 32768
    v_lshrrev_b32 v16, 3, v0
    v_lshlrev_b32 v16, 11, v16
    v_and_b32 v17, 0x70, v1
    v_add_u32 v28, v16, v17
    v_and_b32 v16, 3, v0
    v_lshlrev_b32 v16, 4, v16
    v_and_b32 v17, 4, v0
    v_lshrrev_b32 v18, 5, v0
    v_lshlrev_b32 v18, 3, v18
    v_add3_u32 v16, v16, v17, v18
    v_bfe_u32 v17, v0, 4, 1
    s_lshr_b32 s10, s5, 1
    s_lshl_b32 s10, s10, 6
    s_and_b32 s8, s5, 1
    s_lshl_b32 s8, s8, 1
    s_add_u32 s10, s10, s8
    v_add3_u32 v16, v16, v17, s10
    v_lshlrev_b32 v26, 1, v16
    v_and_b32 v16, 8, v0
    v_lshlrev_b32 v29, 2, v16
    v_lshlrev_b32 v16, 5, v16
    v_and_b32 v18, 3, v0
    v_lshlrev_b32 v18, 6, v18
    v_and_b32 v17, 0x30, v0
    v_add3_u32 v27, v16, v17, v18
    s_lshl_b32 s8, s5, 2
    v_add_u32 v30, s8, v29
    v_and_b32 v16, 32, v0
    v_lshlrev_b32 v16, 2, v16
    v_and_b32 v17, 12, v0
    v_lshlrev_b32 v17, 3, v17
    v_and_b32 v18, 19, v0
    v_add3_u32 v22, v16, v17, v18
    s_mul_i32 s8, s5, 1152
    s_add_u32 s10, s8, 5120
    v_lshl_add_u32 v22, v22, 2, s10
    v_and_b32 v16, 8, v0
    v_add_u32 v31, s8, v16
    v_lshrrev_b32 v16, 3, v0
    v_mul_u32_u24 v24, 1152, v16
    v_and_b32 v17, 0x70, v1
    s_lshl_b32 s8, s5, 7
    v_add3_u32 v23, v24, v17, s8
    v_and_b32 v16, 0x30, v0
    v_lshrrev_b32 v19, 2, v16
    v_lshrrev_b32 v17, 2, v17
    v_lshl_add_u32 v20, v16, 1, v17
    s_lshl_b32 s12, s3, 5
    s_add_u32 s12, s12, s4
    s_mul_i32 s12, s12, 1152
    s_add_u32 s12, s12, 458752
    s_add_u32 s13, s12, s8
    s_waitcnt vmcnt(3)
    s_add_u32 s77, s94, 0
    s_and_b32 s77, s77, 0xfffff
    buffer_load_dwordx4 v[96:99], v210, s[52:55], s77 offen nt
    s_waitcnt vmcnt(3)
    s_add_u32 s77, s94, 368640
    s_and_b32 s77, s77, 0xfffff
    buffer_load_dwordx4 v[100:103], v210, s[52:55], s77 offen nt
    s_lshl_b32 s10, s3, 9
    s_add_u32 s10, s10, 1015808
    v_and_b32 v16, 0x1f0, v1
    buffer_load_dwordx4 v[40:43], v16, s[44:47], s10 offen sc1
    v_mov_b32 v44, v6
    v_mov_b32 v45, v7
    v_mov_b32 v46, v8
    v_mov_b32 v47, v9
    buffer_load_dwordx4 v[32:35], v28, s[44:47], s9 offen sc1
    buffer_load_dwordx4 v[36:39], v28, s[44:47], s11 offen sc1
    s_mov_b64 exec, 0xffff
    buffer_load_dwordx4 v[44:47], v28, s[44:47], s64 offen sc1
    s_mov_b64 exec, -1
    s_waitcnt vmcnt(7)
    s_add_u32 s77, s94, 737280
    s_and_b32 s77, s77, 0xfffff
    buffer_load_dwordx4 v[104:107], v210, s[52:55], s77 offen nt
    s_waitcnt vmcnt(7)
    s_add_u32 s77, s94, 1105920
    s_and_b32 s77, s77, 0xfffff
    buffer_load_dwordx4 v[108:111], v210, s[52:55], s77 offen nt
    s_waitcnt vmcnt(7)
    s_add_u32 s77, s94, 1474560
    s_and_b32 s77, s77, 0xfffff
    buffer_load_dwordx4 v[112:115], v210, s[52:55], s77 offen nt
    s_waitcnt vmcnt(3)
    v_readfirstlane_b32 s10, v40
    v_xor_b32 v17, v40, v6
    v_bitop3_b32 v17, v41, v7, v17 bitop3:0xbe
    v_bitop3_b32 v17, v42, v8, v17 bitop3:0xbe
    v_bitop3_b32 v17, v43, v9, v17 bitop3:0xbe
    v_and_b32 v17, s72, v17
    v_xor_b32 v18, s10, v40
    v_or_b32 v17, v17, v18
    v_cmp_ne_u32 vcc, 0, v17
    s_cmp_eq_u64 vcc, 0
    s_cselect_b32 s74, 1, 0
    v_xor_b32 v32, v32, v6
    v_xor_b32 v33, v33, v7
    v_xor_b32 v34, v34, v8
    v_xor_b32 v35, v35, v9
    v_xor_b32 v36, v36, v6
    v_xor_b32 v37, v37, v7
    v_xor_b32 v38, v38, v8
    v_xor_b32 v39, v39, v9
    v_xor_b32 v44, v44, v6
    v_xor_b32 v45, v45, v7
    v_xor_b32 v46, v46, v8
    v_xor_b32 v47, v47, v9
    v_or3_b32 v236, v32, v33, v34
    v_or3_b32 v237, v35, v36, v37
    v_or3_b32 v238, v38, v39, v44
    v_or3_b32 v239, v45, v46, v47
    v_or3_b32 v240, v236, v237, v238
    v_bitop3_b32 v21, v239, v240, s72 bitop3:0xa8
    v_cmp_ne_u32 vcc, 0, v21
    s_cbranch_vccz L_qok57
    s_mov_b32 s7, 0
L_poll58:
    v_mov_b32 v44, v6
    v_mov_b32 v45, v7
    v_mov_b32 v46, v8
    v_mov_b32 v47, v9
    buffer_load_dwordx4 v[32:35], v28, s[44:47], s9 offen sc1
    buffer_load_dwordx4 v[36:39], v28, s[44:47], s11 offen sc1
    s_mov_b64 exec, 0xffff
    buffer_load_dwordx4 v[44:47], v28, s[44:47], s64 offen sc1
    s_mov_b64 exec, -1
    s_add_u32 s7, s7, 1
    s_cmp_gt_u32 s7, 400000
    s_cbranch_scc1 L_end
    s_waitcnt vmcnt(0)
    v_xor_b32 v32, v32, v6
    v_xor_b32 v33, v33, v7
    v_xor_b32 v34, v34, v8
    v_xor_b32 v35, v35, v9
    v_xor_b32 v36, v36, v6
    v_xor_b32 v37, v37, v7
    v_xor_b32 v38, v38, v8
    v_xor_b32 v39, v39, v9
    v_xor_b32 v44, v44, v6
    v_xor_b32 v45, v45, v7
    v_xor_b32 v46, v46, v8
    v_xor_b32 v47, v47, v9
    v_or3_b32 v236, v32, v33, v34
    v_or3_b32 v237, v35, v36, v37
    v_or3_b32 v238, v38, v39, v44
    v_or3_b32 v239, v45, v46, v47
    v_or3_b32 v240, v236, v237, v238
    v_bitop3_b32 v21, v239, v240, s72 bitop3:0xa8
    v_cmp_ne_u32 vcc, 0, v21
    s_cbranch_vccnz L_poll58
L_qok57:
    s_waitcnt vmcnt(7)
    s_add_u32 s77, s94, 1843200
    s_and_b32 s77, s77, 0xfffff
    buffer_load_dwordx4 v[116:119], v210, s[52:55], s77 offen nt
    v_pk_add_f32 v[32:33], v[32:33], v[44:45]
    v_pk_add_f32 v[34:35], v[34:35], v[46:47]
    v_pk_add_f32 v[32:33], v[32:33], v[36:37]
    v_pk_add_f32 v[34:35], v[34:35], v[38:39]
    s_nop 1
    v_permlane32_swap_b32 v32, v34
    v_permlane32_swap_b32 v33, v35
    v_pk_add_f32 v[32:33], v[32:33], v[34:35]
    s_nop 1
    v_permlane16_swap_b32 v32, v33
    v_add_f32 v32, v32, v33
    s_nop 1
    v_add_f32_dpp v32, v32, v32 row_ror:8 row_mask:0xf bank_mask:0xf
    v_cvt_pk_bf16_f32 v32, v32, v32
    ds_write_b16 v26, v32 offset:14336
    s_waitcnt lgkmcnt(0)
    s_barrier
    ds_read_b128 v[32:35], v27 offset:14336
    s_add_u32 s77, s94, 2211840
    s_and_b32 s77, s77, 0xfffff
    buffer_load_dwordx4 v[120:123], v210, s[52:55], s77 offen nt
    s_add_u32 s77, s94, 2580480
    s_and_b32 s77, s77, 0xfffff
    buffer_load_dwordx4 v[124:127], v210, s[52:55], s77 offen nt
    s_waitcnt lgkmcnt(0)
    v_cndmask_b32 v36, v32, 0, s[86:87]
    v_cndmask_b32 v37, v33, 0, s[86:87]
    v_cndmask_b32 v38, v34, 0, s[86:87]
    v_cndmask_b32 v39, v35, 0, s[86:87]
    v_cndmask_b32 v32, 0, v32, s[86:87]
    v_cndmask_b32 v33, 0, v33, s[86:87]
    v_cndmask_b32 v34, 0, v34, s[86:87]
    v_cndmask_b32 v35, 0, v35, s[86:87]
    v_mfma_f32_16x16x32_bf16 v[40:43], v[68:71], v[36:39], 0
    v_mfma_f32_16x16x32_bf16 v[44:47], v[76:79], v[36:39], 0
    v_mfma_f32_16x16x32_bf16 v[48:51], v[84:87], v[36:39], 0
    v_mfma_f32_16x16x32_bf16 v[52:55], v[92:95], v[36:39], 0
    v_mfma_f32_16x16x32_bf16 v[40:43], v[64:67], v[32:35], v[40:43]
    v_mfma_f32_16x16x32_bf16 v[44:47], v[72:75], v[32:35], v[44:47]
    v_mfma_f32_16x16x32_bf16 v[48:51], v[80:83], v[32:35], v[48:51]
    v_mfma_f32_16x16x32_bf16 v[52:55], v[88:91], v[32:35], v[52:55]
    s_lshl_b32 s12, s3, 5
    s_add_u32 s12, s12, s4
    s_lshl_b32 s12, s12, 4
    s_add_u32 s12, s12, 1024000
    s_lshl_b32 s8, s5, 3
    s_mov_b32 s10, 0x00010001
    s_mov_b32 s11, 0x00010001
    v_mov_b32_dpp v56, v40 quad_perm:[0,0,0,0] row_mask:0xf bank_mask:0xf
    v_add_f32_dpp v56, v41, v56 quad_perm:[1,1,1,1] row_mask:0xf bank_mask:0xf
    v_add_f32_dpp v56, v42, v56 quad_perm:[2,2,2,2] row_mask:0xf bank_mask:0xf
    v_add_f32_dpp v56, v43, v56 quad_perm:[3,3,3,3] row_mask:0xf bank_mask:0xf
    v_mov_b32_dpp v57, v44 quad_perm:[0,0,0,0] row_mask:0xf bank_mask:0xf
    v_add_f32_dpp v57, v45, v57 quad_perm:[1,1,1,1] row_mask:0xf bank_mask:0xf
    v_add_f32_dpp v57, v46, v57 quad_perm:[2,2,2,2] row_mask:0xf bank_mask:0xf
    v_add_f32_dpp v57, v47, v57 quad_perm:[3,3,3,3] row_mask:0xf bank_mask:0xf
    v_mov_b32_dpp v58, v48 quad_perm:[0,0,0,0] row_mask:0xf bank_mask:0xf
    v_add_f32_dpp v58, v49, v58 quad_perm:[1,1,1,1] row_mask:0xf bank_mask:0xf
    v_add_f32_dpp v58, v50, v58 quad_perm:[2,2,2,2] row_mask:0xf bank_mask:0xf
    v_add_f32_dpp v58, v51, v58 quad_perm:[3,3,3,3] row_mask:0xf bank_mask:0xf
    v_mov_b32_dpp v59, v52 quad_perm:[0,0,0,0] row_mask:0xf bank_mask:0xf
    v_add_f32_dpp v59, v53, v59 quad_perm:[1,1,1,1] row_mask:0xf bank_mask:0xf
    v_add_f32_dpp v59, v54, v59 quad_perm:[2,2,2,2] row_mask:0xf bank_mask:0xf
    v_add_f32_dpp v59, v55, v59 quad_perm:[3,3,3,3] row_mask:0xf bank_mask:0xf
    v_cvt_pk_bf16_f32 v60, v56, v57
    v_lshlrev_b32 v56, 16, v60
    v_and_b32 v57, s73, v60
    v_cvt_pk_bf16_f32 v61, v58, v59
    v_lshlrev_b32 v58, 16, v61
    v_and_b32 v59, s73, v61
    v_mul_f32 v56, 0x3db504f3, v56
    v_mul_f32 v57, 0x3db504f3, v57
    v_mul_f32 v58, 0x3db504f3, v58
    v_mul_f32 v59, 0x3db504f3, v59
    v_cvt_pk_bf16_f32 v60, v56, v57
    v_lshlrev_b32 v56, 16, v60
    v_and_b32 v57, s73, v60
    v_cvt_pk_bf16_f32 v61, v58, v59
    v_lshlrev_b32 v58, 16, v61
    v_and_b32 v59, s73, v61
    v_max3_f32 v60, v56, v57, v58
    v_max_f32 v60, v60, v59
    s_nop 1
    v_max_f32_dpp v60, v60, v60 row_half_mirror row_mask:0xf bank_mask:0xf
    v_mov_b32 v61, v60
    s_nop 1
    v_permlane16_swap_b32 v60, v61
    v_max_f32 v60, v60, v61
    v_mov_b32 v61, v60
    s_nop 1
    v_permlane32_swap_b32 v60, v61
    v_max_f32 v60, v60, v61
    v_sub_f32 v56, v56, v60
    v_sub_f32 v57, v57, v60
    v_sub_f32 v58, v58, v60
    v_sub_f32 v59, v59, v60
    v_mul_f32 v56, s76, v56
    v_mul_f32 v57, s76, v57
    v_mul_f32 v58, s76, v58
    v_mul_f32 v59, s76, v59
    v_exp_f32 v56, v56
    v_exp_f32 v57, v57
    v_exp_f32 v58, v58
    v_exp_f32 v59, v59
    v_cvt_pk_bf16_f32 v56, v56, v56
    v_cvt_pk_bf16_f32 v57, v57, v57
    v_cvt_pk_bf16_f32 v58, v58, v58
    v_cvt_pk_bf16_f32 v59, v59, v59
    v_and_b32 v44, s73, v56
    v_and_b32 v45, s73, v57
    v_and_b32 v46, s73, v58
    v_and_b32 v47, s73, v59
    v_add_f32 v44, v44, v45
    v_add_f32 v46, v46, v47
    v_add_f32 v61, v44, v46
    v_and_b32 v64, v56, v2
    v_and_b32 v65, v56, v3
    v_and_b32_dpp v66, v56, v4 row_shr:4 row_mask:0xf bank_mask:0xf bound_ctrl:0
    v_and_b32_dpp v67, v56, v5 row_shr:4 row_mask:0xf bank_mask:0xf bound_ctrl:0
    v_add_f32_dpp v61, v61, v61 row_half_mirror row_mask:0xf bank_mask:0xf
    v_mov_b32 v44, v61
    v_and_b32_dpp v68, v56, v2 row_shl:4 row_mask:0xf bank_mask:0xf bound_ctrl:0
    v_and_b32_dpp v69, v56, v3 row_shl:4 row_mask:0xf bank_mask:0xf bound_ctrl:0
    v_and_b32 v70, v56, v4
    v_and_b32 v71, v56, v5
    v_permlane16_swap_b32 v61, v44
    v_add_f32 v61, v61, v44
    v_mov_b32 v44, v61
    v_and_b32 v72, v57, v2
    v_and_b32 v73, v57, v3
    v_and_b32_dpp v74, v57, v4 row_shr:4 row_mask:0xf bank_mask:0xf bound_ctrl:0
    v_and_b32_dpp v75, v57, v5 row_shr:4 row_mask:0xf bank_mask:0xf bound_ctrl:0
    v_permlane32_swap_b32 v61, v44
    v_add_f32 v61, v61, v44
    s_mov_b64 exec, 0x101
    ds_write_b64 v31, v[60:61] offset:6144
    s_mov_b64 exec, -1
    v_and_b32_dpp v76, v57, v2 row_shl:4 row_mask:0xf bank_mask:0xf bound_ctrl:0
    v_and_b32_dpp v77, v57, v3 row_shl:4 row_mask:0xf bank_mask:0xf bound_ctrl:0
    v_and_b32 v78, v57, v4
    v_and_b32 v79, v57, v5
    v_and_b32 v80, v58, v2
    v_and_b32 v81, v58, v3
    v_and_b32_dpp v82, v58, v4 row_shr:4 row_mask:0xf bank_mask:0xf bound_ctrl:0
    v_and_b32_dpp v83, v58, v5 row_shr:4 row_mask:0xf bank_mask:0xf bound_ctrl:0
    v_and_b32_dpp v84, v58, v2 row_shl:4 row_mask:0xf bank_mask:0xf bound_ctrl:0
    v_and_b32_dpp v85, v58, v3 row_shl:4 row_mask:0xf bank_mask:0xf bound_ctrl:0
    v_and_b32 v86, v58, v4
    v_and_b32 v87, v58, v5
    v_and_b32 v88, v59, v2
    v_and_b32 v89, v59, v3
    v_and_b32_dpp v90, v59, v4 row_shr:4 row_mask:0xf bank_mask:0xf bound_ctrl:0
    v_and_b32_dpp v91, v59, v5 row_shr:4 row_mask:0xf bank_mask:0xf bound_ctrl:0
    v_and_b32_dpp v92, v59, v2 row_shl:4 row_mask:0xf bank_mask:0xf bound_ctrl:0
    v_and_b32_dpp v93, v59, v3 row_shl:4 row_mask:0xf bank_mask:0xf bound_ctrl:0
    v_and_b32 v94, v59, v4
    v_and_b32 v95, v59, v5
    s_waitcnt lgkmcnt(0)
    s_barrier
    ds_read_b128 v[44:47], v24 offset:6144
    s_waitcnt vmcnt(11)
    v_mfma_f32_16x16x32_bf16 v[40:43], v[64:67], v[96:99], 0
    s_waitcnt vmcnt(10)
    v_mfma_f32_16x16x32_bf16 v[40:43], v[68:71], v[100:103], v[40:43]
    s_waitcnt vmcnt(5)
    v_mfma_f32_16x16x32_bf16 v[40:43], v[72:75], v[104:107], v[40:43]
    s_waitcnt lgkmcnt(0)
    v_max_f32_dpp v48, v44, v44 row_ror:8 row_mask:0xf bank_mask:0xf
    v_max_f32_dpp v50, v46, v46 row_ror:8 row_mask:0xf bank_mask:0xf
    v_mov_b32 v49, v48
    v_mov_b32 v51, v50
    s_nop 0
    v_permlane16_swap_b32 v48, v49
    v_permlane16_swap_b32 v50, v51
    v_max_f32 v48, v48, v49
    v_max_f32 v50, v50, v51
    v_mov_b32 v49, v48
    v_mov_b32 v51, v50
    s_nop 0
    v_permlane32_swap_b32 v48, v49
    v_permlane32_swap_b32 v50, v51
    v_max_f32 v48, v48, v49
    v_max_f32 v50, v50, v51
    v_sub_f32 v49, v44, v48
    v_sub_f32 v51, v46, v50
    v_mul_f32 v49, s76, v49
    v_mul_f32 v51, s76, v51
    v_exp_f32 v49, v49
    v_exp_f32 v51, v51
    v_mul_f32 v44, 0x3e000000, v48
    v_mul_f32 v46, 0x3e000000, v50
    v_mul_f32 v45, v45, v49
    v_mul_f32 v47, v47, v51
    v_readlane_b32 s9, v49, s8
    v_readlane_b32 s8, v51, s8
    v_permlane32_swap_b32 v44, v46
    v_permlane32_swap_b32 v45, v47
    v_add_f32 v44, v44, v46
    v_add_f32 v45, v45, v47
    s_nop 1
    v_permlane16_swap_b32 v44, v45
    v_add_f32 v44, v44, v45
    v_mov_b32 v48, s9
    v_mov_b32 v49, s8
    v_add_f32_dpp v44, v44, v44 row_ror:8 row_mask:0xf bank_mask:0xf
    v_cndmask_b32 v48, v48, v49, s[90:91]
    v_bfi_b32 v44, s72, v202, v44
    s_mov_b64 exec, s[10:11]
    s_cmp_eq_u32 s74, 0
    s_cbranch_scc1 L_ls59
    buffer_store_dword v44, v19, s[44:47], s12 offen
    s_branch L_le60
L_ls59:
    buffer_store_dword v44, v19, s[44:47], s12 offen sc1
L_le60:
    s_mov_b64 exec, -1
    s_waitcnt vmcnt(5)
    v_mfma_f32_16x16x32_bf16 v[40:43], v[76:79], v[108:111], v[40:43]
    s_waitcnt vmcnt(4)
    v_mfma_f32_16x16x32_bf16 v[40:43], v[80:83], v[112:115], v[40:43]
    s_waitcnt vmcnt(3)
    v_mfma_f32_16x16x32_bf16 v[40:43], v[84:87], v[116:119], v[40:43]
    s_waitcnt vmcnt(2)
    v_mfma_f32_16x16x32_bf16 v[40:43], v[88:91], v[120:123], v[40:43]
    s_waitcnt vmcnt(1)
    v_mfma_f32_16x16x32_bf16 v[40:43], v[92:95], v[124:127], v[40:43]
    s_nop 7
    v_mul_f32 v40, v40, v48
    v_mul_f32 v41, v41, v48
    v_mul_f32 v42, v42, v48
    v_mul_f32 v43, v43, v48
    ds_write2_b32 v22, v40, v41 offset0:0 offset1:4
    ds_write2_b32 v22, v42, v43 offset0:8 offset1:12
    s_waitcnt lgkmcnt(0)
    s_barrier
    ds_read_b128 v[40:43], v23 offset:5120
    s_waitcnt lgkmcnt(0)
    v_permlane32_swap_b32 v40, v42
    v_permlane32_swap_b32 v41, v43
    v_add_f32 v40, v40, v42
    v_add_f32 v41, v41, v43
    s_nop 1
    v_permlane16_swap_b32 v40, v41
    v_add_f32 v40, v40, v41
    s_nop 1
    v_add_f32_dpp v40, v40, v40 row_ror:8 row_mask:0xf bank_mask:0xf
    v_bfi_b32 v40, s72, v216, v40
    s_mov_b64 exec, s[84:85]
    s_cmp_eq_u32 s74, 0
    s_cbranch_scc1 L_ls61
    buffer_store_dword v40, v20, s[44:47], s13 offen
    s_branch L_le62
L_ls61:
    buffer_store_dword v40, v20, s[44:47], s13 offen sc1
L_le62:
    s_mov_b64 exec, -1
    s_sub_u32 s8, s4, 27
    s_lshl_b32 s8, s8, 1
    s_add_u32 s8, s8, s5
    s_cmp_gt_u32 s5, 1
    s_cbranch_scc1 L_fin
    s_cmp_gt_u32 s8, 8
    s_cbranch_scc1 L_fin
    s_mov_b32 s68, s16
    s_mov_b32 s69, s17
    s_mov_b32 s70, 1152
    s_mov_b32 s71, 0x20000
    s_lshl_b32 s9, s8, 7
    v_lshlrev_b32 v25, 1, v0
    buffer_load_ushort v62, v25, s[68:71], s9 offen
    s_mul_i32 s12, s3, 6912
    s_add_u32 s12, s12, 1703936
    s_lshl_b32 s13, s8, 4
    s_add_u32 s13, s13, s12
    s_add_u32 s13, s13, 4608
    s_lshl_b32 s8, s8, 8
    s_add_u32 s12, s12, s8
    s_add_u32 s10, s8, 1835008
    s_add_u32 s11, s10, 4608
    v_lshrrev_b32 v16, 4, v0
    v_lshlrev_b32 v26, 2, v16
    v_mul_u32_u24 v16, 2304, v16
    v_and_b32 v17, 0xf0, v1
    v_add_u32 v27, v16, v17
    s_add_u32 s14, s8, 786432
    s_add_u32 s15, s14, 9216
    s_mul_i32 s64, s3, 2304
    s_add_u32 s64, s64, 950272
    s_add_u32 s64, s64, s8
    s_mov_b32 s66, 0x00010001
    s_mov_b32 s67, 0x00010001
    s_movk_i32 s68, 9216
    v_lshrrev_b32 v16, 4, v0
    v_mul_u32_u24 v16, 9216, v16
    v_add3_u32 v24, v16, v17, s68
    s_mov_b32 s7, 0
L_poll63:
    buffer_load_dword v56, v234, s[44:47], s10 offen offset:0 sc1
    buffer_load_dwordx4 v[40:43], v24, s[44:47], s10 offen offset:0 sc1
    buffer_load_dword v57, v234, s[44:47], s10 offen offset:2304 sc1
    buffer_load_dwordx4 v[44:47], v24, s[44:47], s10 offen offset:2304 sc1
    buffer_load_dword v58, v234, s[44:47], s11 offen offset:0 sc1
    buffer_load_dwordx4 v[48:51], v24, s[44:47], s11 offen offset:0 sc1
    buffer_load_dword v59, v234, s[44:47], s11 offen offset:2304 sc1
    buffer_load_dwordx4 v[52:55], v24, s[44:47], s11 offen offset:2304 sc1
    s_add_u32 s7, s7, 1
    s_cmp_gt_u32 s7, 400000
    s_cbranch_scc1 L_end
    s_waitcnt vmcnt(0)
    v_xor_b32 v56, v56, v216
    v_xor_b32 v57, v57, v216
    v_xor_b32 v58, v58, v216
    v_xor_b32 v59, v59, v216
    v_xor_b32 v40, v40, v6
    v_xor_b32 v41, v41, v7
    v_xor_b32 v42, v42, v8
    v_xor_b32 v43, v43, v9
    v_xor_b32 v44, v44, v6
    v_xor_b32 v45, v45, v7
    v_xor_b32 v46, v46, v8
    v_xor_b32 v47, v47, v9
    v_xor_b32 v48, v48, v6
    v_xor_b32 v49, v49, v7
    v_xor_b32 v50, v50, v8
    v_xor_b32 v51, v51, v9
    v_xor_b32 v52, v52, v6
    v_xor_b32 v53, v53, v7
    v_xor_b32 v54, v54, v8
    v_xor_b32 v55, v55, v9
    v_or3_b32 v236, v56, v57, v58
    v_or3_b32 v237, v59, v40, v41
    v_or3_b32 v238, v42, v43, v44
    v_or3_b32 v239, v45, v46, v47
    v_or3_b32 v240, v48, v49, v50
    v_or3_b32 v241, v51, v52, v53
    v_or3_b32 v242, v54, v55, v236
    v_or3_b32 v243, v237, v238, v239
    v_or3_b32 v236, v240, v241, v242
    v_bitop3_b32 v21, v243, v236, s72 bitop3:0xa8
    v_cmp_ne_u32 vcc, 0, v21
    s_cbranch_vccnz L_poll63
    v_permlane32_swap_b32 v40, v42
    v_permlane32_swap_b32 v41, v43
    v_add_f32 v40, v40, v42
    v_add_f32 v41, v41, v43
    s_nop 1
    v_permlane16_swap_b32 v40, v41
    v_add_f32 v40, v40, v41
    v_add_f32 v56, v56, v40
    v_cvt_pk_bf16_f32 v56, v56, v56
    v_and_b32 v56, s73, v56
    v_permlane32_swap_b32 v44, v46
    v_permlane32_swap_b32 v45, v47
    v_add_f32 v44, v44, v46
    v_add_f32 v45, v45, v47
    s_nop 1
    v_permlane16_swap_b32 v44, v45
    v_add_f32 v44, v44, v45
    v_add_f32 v57, v57, v44
    v_cvt_pk_bf16_f32 v57, v57, v57
    v_and_b32 v57, s73, v57
    v_permlane32_swap_b32 v48, v50
    v_permlane32_swap_b32 v49, v51
    v_add_f32 v48, v48, v50
    v_add_f32 v49, v49, v51
    s_nop 1
    v_permlane16_swap_b32 v48, v49
    v_add_f32 v48, v48, v49
    v_add_f32 v58, v58, v48
    v_cvt_pk_bf16_f32 v58, v58, v58
    v_and_b32 v58, s73, v58
    v_permlane32_swap_b32 v52, v54
    v_permlane32_swap_b32 v53, v55
    v_add_f32 v52, v52, v54
    v_add_f32 v53, v53, v55
    s_nop 1
    v_permlane16_swap_b32 v52, v53
    v_add_f32 v52, v52, v53
    v_add_f32 v59, v59, v52
    v_cvt_pk_bf16_f32 v59, v59, v59
    v_and_b32 v59, s73, v59
    v_add_f32 v58, 1.0, v58
    v_cvt_pk_bf16_f32 v58, v58, v58
    v_and_b32 v58, s73, v58
    v_or_b32 v60, v58, v216
    v_or_b32 v61, v57, v216
    v_lshlrev_b32 v62, 16, v62
    s_cmp_eq_u32 s74, 0
    s_cbranch_scc1 L_ls64
    buffer_store_dword v60, v234, s[44:47], s12 offen
    buffer_store_dword v61, v234, s[44:47], s12 offen offset:2304
    s_branch L_le65
L_ls64:
    buffer_store_dword v60, v234, s[44:47], s12 offen sc1
    buffer_store_dword v61, v234, s[44:47], s12 offen offset:2304 sc1
L_le65:
    s_mov_b64 s[96:97], -1
    s_mov_b64 s[98:99], -1
    s_mov_b32 s7, 0
L_mp66:
    s_mov_b64 exec, s[96:97]
    s_cbranch_execz L_ms68
    buffer_load_dwordx4 v[32:35], v27, s[44:47], s14 offen sc1
L_ms68:
    s_mov_b64 exec, s[98:99]
    s_cbranch_execz L_ms69
    buffer_load_dwordx4 v[36:39], v27, s[44:47], s15 offen sc1
L_ms69:
    s_add_u32 s7, s7, 1
    s_cmp_gt_u32 s7, 400000
    s_cbranch_scc1 L_end
    s_waitcnt vmcnt(0)
    s_mov_b64 exec, s[96:97]
    s_cbranch_execz L_mc70
    v_xor_b32 v32, v32, v6
    v_xor_b32 v33, v33, v7
    v_xor_b32 v34, v34, v8
    v_xor_b32 v35, v35, v9
    v_or3_b32 v236, v32, v33, v34
    v_bitop3_b32 v21, v35, v236, s72 bitop3:0xa8
    v_cmp_ne_u32 s[96:97], 0, v21
L_mc70:
    s_mov_b64 exec, s[98:99]
    s_cbranch_execz L_mc71
    v_xor_b32 v36, v36, v6
    v_xor_b32 v37, v37, v7
    v_xor_b32 v38, v38, v8
    v_xor_b32 v39, v39, v9
    v_or3_b32 v236, v36, v37, v38
    v_bitop3_b32 v21, v39, v236, s72 bitop3:0xa8
    v_cmp_ne_u32 s[98:99], 0, v21
L_mc71:
    s_or_b64 vcc, s[96:97], s[98:99]
    s_mov_b64 exec, -1
    s_cbranch_scc1 L_mp66
L_md67:
    v_pk_add_f32 v[32:33], v[32:33], v[36:37]
    v_pk_add_f32 v[34:35], v[34:35], v[38:39]
    s_nop 1
    v_permlane32_swap_b32 v32, v34
    v_permlane32_swap_b32 v33, v35
    v_pk_add_f32 v[32:33], v[32:33], v[34:35]
    s_nop 1
    v_permlane16_swap_b32 v32, v33
    v_add_f32 v32, v32, v33
    v_fma_f32 v62, v32, v56, v62
    v_mov_b32 v36, v62
    v_mul_f32 v37, v62, v62
    v_mul_f32 v33, v62, v58
    v_bfi_b32 v33, s72, v216, v33
    v_permlane32_swap_b32 v36, v37
    v_add_f32 v36, v36, v37
    s_nop 1
    v_add_f32_dpp v36, v36, v36 row_ror:8 row_mask:0xf bank_mask:0xf
    s_nop 1
    v_add_f32_dpp v36, v36, v36 row_ror:4 row_mask:0xf bank_mask:0xf
    s_nop 1
    v_add_f32_dpp v36, v36, v36 row_ror:2 row_mask:0xf bank_mask:0xf
    s_nop 1
    v_add_f32_dpp v36, v36, v36 row_ror:1 row_mask:0xf bank_mask:0xf
    v_bfi_b32 v36, s72, v202, v36
    s_cmp_eq_u32 s74, 0
    s_cbranch_scc1 L_ls72
    buffer_store_dword v33, v234, s[44:47], s64 offen
    s_mov_b64 exec, s[66:67]
    buffer_store_dword v36, v26, s[44:47], s13 offen
    s_mov_b64 exec, -1
    s_branch L_le73
L_ls72:
    buffer_store_dword v33, v234, s[44:47], s64 offen sc1
    s_mov_b64 exec, s[66:67]
    buffer_store_dword v36, v26, s[44:47], s13 offen sc1
    s_mov_b64 exec, -1
L_le73:
    s_lshr_b32 s10, s8, 8
    s_and_b32 s10, s10, 7
    s_cmp_lg_u32 s10, s3
    s_cbranch_scc1 L_fin
    s_mov_b32 s64, s38
    s_mov_b32 s65, s39
    s_mov_b32 s66, 1152
    s_mov_b32 s67, 0x20000
    buffer_load_ushort v205, v25, s[64:67], s9 offen
    s_add_u32 s14, s8, 917504
    s_add_u32 s15, s14, 9216
    s_mov_b64 s[96:97], -1
    s_mov_b64 s[98:99], -1
    s_mov_b32 s7, 0
L_mp74:
    s_mov_b64 exec, s[96:97]
    s_cbranch_execz L_ms76
    buffer_load_dwordx4 v[32:35], v27, s[44:47], s14 offen sc1
L_ms76:
    s_mov_b64 exec, s[98:99]
    s_cbranch_execz L_ms77
    buffer_load_dwordx4 v[36:39], v27, s[44:47], s15 offen sc1
L_ms77:
    s_add_u32 s7, s7, 1
    s_cmp_gt_u32 s7, 400000
    s_cbranch_scc1 L_end
    s_waitcnt vmcnt(0)
    s_mov_b64 exec, s[96:97]
    s_cbranch_execz L_mc78
    v_xor_b32 v32, v32, v6
    v_xor_b32 v33, v33, v7
    v_xor_b32 v34, v34, v8
    v_xor_b32 v35, v35, v9
    v_or3_b32 v236, v32, v33, v34
    v_bitop3_b32 v21, v35, v236, s72 bitop3:0xa8
    v_cmp_ne_u32 s[96:97], 0, v21
L_mc78:
    s_mov_b64 exec, s[98:99]
    s_cbranch_execz L_mc79
    v_xor_b32 v36, v36, v6
    v_xor_b32 v37, v37, v7
    v_xor_b32 v38, v38, v8
    v_xor_b32 v39, v39, v9
    v_or3_b32 v236, v36, v37, v38
    v_bitop3_b32 v21, v39, v236, s72 bitop3:0xa8
    v_cmp_ne_u32 s[98:99], 0, v21
L_mc79:
    s_or_b64 vcc, s[96:97], s[98:99]
    s_mov_b64 exec, -1
    s_cbranch_scc1 L_mp74
L_md75:
    v_pk_add_f32 v[32:33], v[32:33], v[36:37]
    v_pk_add_f32 v[34:35], v[34:35], v[38:39]
    s_nop 1
    v_permlane32_swap_b32 v32, v34
    v_permlane32_swap_b32 v33, v35
    v_pk_add_f32 v[32:33], v[32:33], v[34:35]
    s_nop 1
    v_permlane16_swap_b32 v32, v33
    v_add_f32 v32, v32, v33
    v_fma_f32 v32, v32, v59, v62
    v_cvt_pk_bf16_f32 v32, v32, v32
    buffer_store_short v32, v25, s[64:67], s9 offen
    s_cmp_lg_u32 s8, 0
    s_cbranch_scc1 L_fin
    s_mov_b64 exec, 1
    buffer_store_dwordx2 v[206:207], off, s[44:47], 0 sc1
    s_mov_b64 exec, -1
L_fin:
L_end:
    s_endpgm
L_code_end:
.section .rodata,"a"
.p2align 6
.amdhsa_kernel adaLN_cond__sliding_block_cached__glu_gated_geglu__decode_kernel
  .amdhsa_next_free_vgpr 244
  .amdhsa_next_free_sgpr 102
  .amdhsa_accum_offset 244
  .amdhsa_group_segment_fixed_size 0
  .amdhsa_kernarg_size 112
  .amdhsa_user_sgpr_count 2
  .amdhsa_user_sgpr_kernarg_segment_ptr 1
  .amdhsa_system_sgpr_workgroup_id_x 1
.end_amdhsa_kernel
```
